```python
import torch

def _softmax(x, axis=-1):
    return torch.softmax(x, dim=axis)

def _gelu(x):
    return torch.nn.functional.gelu(x, approximate='tanh')

def _silu(x):
    return torch.nn.functional.silu(x)

def _sigmoid(x):
    return torch.sigmoid(x)

def _layernorm(x, axis=-1, eps=1e-05):
    m = x.mean(dim=axis, keepdim=True)
    v = x.var(dim=axis, keepdim=True, unbiased=False)
    return (x - m) / torch.sqrt(v + eps)

def _scatter_add(tgt, idx, src, axis=0):
    return tgt.clone().index_add_(axis, idx, src)

def _segment_sum(src, seg, n):
    out = torch.zeros((n,) + src.shape[1:], dtype=src.dtype)
    return out.index_add_(0, seg, src)

def _pad(x, pw):
    flat = tuple((v for pair in reversed(pw) for v in pair))
    return torch.nn.functional.pad(x, flat)
kernel_name = 'adaLN_cond__ssm_conv_h3__dense_activation_silu__prompt'

def setup_inputs():

    _w = lambda a: (lambda t: t.to(torch.bfloat16) if t.is_floating_point() else t)(torch.as_tensor(a))

    def _A_setup():
        B, S, D = (1, 2048, 512)
        ks = 4
        return {'q': _w((lambda *s: torch.randn(*s, dtype=torch.bfloat16) * 0.05)(B, S, D)), 'k': _w((lambda *s: torch.randn(*s, dtype=torch.bfloat16) * 0.8)(B, S, D)), 'v': _w((lambda *s: torch.randn(*s, dtype=torch.bfloat16) * 0.8)(B, S, D)), 'shift_k': _w((lambda *s: torch.randn(*s, dtype=torch.bfloat16) * 0.8)(D, ks) * 0.5), 'ssm_k': _w((lambda *s: torch.randn(*s, dtype=torch.bfloat16) * 0.8)(D, S) * (1.0 / S ** 0.5)), 'ssm_D': _w((lambda *s: torch.randn(*s, dtype=torch.bfloat16) * 0.8)(D))}
    _A_in = _A_setup()

    def _B_setup():
        B, S, D, F = (1, 2048, 512, 1792)
        return {'x': _w((lambda *s: torch.randn(*s, dtype=torch.bfloat16) * 0.05)(B, S, D)), 'w1': _w((lambda *s: torch.randn(*s, dtype=torch.bfloat16) * 3.2)(D, F) * D ** (-0.5)), 'w2': _w((lambda *s: torch.randn(*s, dtype=torch.bfloat16) * 0.8)(F, D) * F ** (-0.5))}
    _B_in = _B_setup()
    return {'A_q': _A_in['q'], 'A_k': _A_in['k'], 'A_v': _A_in['v'], 'A_shift_k': _A_in['shift_k'], 'A_ssm_k': _A_in['ssm_k'], 'A_ssm_D': _A_in['ssm_D'], 'B_x': _B_in['x'], 'B_w1': _B_in['w1'], 'B_w2': _B_in['w2'], 'c': _w((lambda *s: torch.randn(*s, dtype=torch.bfloat16) * 0.2)(1, 512) * 8.0), 'w_mod': _w((lambda *s: torch.randn(*s, dtype=torch.bfloat16) * 0.2)(512, 6 * 512) * 512 ** (-0.5) * 8.0)}

def reference(A_q, A_k, A_v, A_shift_k, A_ssm_k, A_ssm_D, B_x, B_w1, B_w2, c, w_mod):

    def _A_ref(q, k, v, shift_k, ssm_k, ssm_D):
        B, S, D = q.shape
        ks = shift_k.shape[-1]
        k_pad = _pad(k, ((0, 0), (ks - 1, 0), (0, 0)))
        k_shift = torch.zeros_like(k)
        for t in range(ks):
            k_shift = k_shift + k_pad[:, t:t + S, :] * shift_k[:, ks - 1 - t][None, None, :]
        kv = k_shift * v
        L = 2 * S
        kv_pad = _pad(kv, ((0, 0), (0, S), (0, 0)))
        kf_pad = _pad(ssm_k, ((0, 0), (0, S)))
        kv_f = (lambda x, axes=(-2, -1): torch.fft.rfft2(x.float(), dim=axes))(kv_pad[:, None, :, :], axes=(1, 2))
        kf_f = (lambda x, axes=(-2, -1): torch.fft.rfft2(x.float(), dim=axes))(kf_pad[:, None, :], axes=(1, 2))
        kf_f = (lambda x, *d: x.permute(*d))(kf_f, 1, 2, 0)
        y_f = kv_f * kf_f[None, :, :, :]
        y = (lambda x, s, axes=(-2, -1): torch.fft.irfft2(x, s=s, dim=axes).to(torch.bfloat16))(y_f, (1, L), axes=(1, 2))[:, 0, :S, :]
        y = y + kv * ssm_D[None, None, :]
        return q * y

    def _B_ref(x, w1, w2):
        h = torch.einsum('bsd,df->bsf', x, w1)
        h = _silu(h)
        out = torch.einsum('bsf,fd->bsd', h, w2)
        return out
    x = A_q
    mod = (_silu(c) @ w_mod).reshape(c.shape[0], 6, 1, -1)
    sa, ca, ga, sb, cb, gb = (mod[:, 0].clone(), mod[:, 1].clone(), mod[:, 2].clone(), mod[:, 3].clone(), mod[:, 4].clone(), mod[:, 5].clone())
    h = _layernorm(x, axis=-1) * (1 + ca) + sa
    x = x + ga * _A_ref(h, A_k, A_v, A_shift_k, A_ssm_k, A_ssm_D)
    h = _layernorm(x, axis=-1) * (1 + cb) + sb
    x = x + gb * _B_ref(h, B_w1, B_w2)
    return x
```

```asm
; @launch grid=(256,1,1) block=(256,1,1) lds=163840
.amdgcn_target "amdgcn-amd-amdhsa--gfx950"
.text
.globl adaLN_cond__ssm_conv_h3__dense_activation_silu__prompt_kernel
.p2align 8
.type adaLN_cond__ssm_conv_h3__dense_activation_silu__prompt_kernel,@function
adaLN_cond__ssm_conv_h3__dense_activation_silu__prompt_kernel:
    s_cmp_ge_u32 s2, 256
    s_cbranch_scc1 L_end_adaLN_cond__ssm_conv_h3__dense_activation_silu__prompt_kernel
    s_load_dwordx2 s[12:13], s[0:1], 8
    s_load_dwordx2 s[16:17], s[0:1], 16
    s_load_dwordx2 s[20:21], s[0:1], 24
    s_load_dwordx2 s[40:41], s[0:1], 72
    s_load_dwordx2 s[44:45], s[0:1], 80
    s_load_dwordx2 s[8:9], s[0:1], 0
    s_load_dwordx2 s[52:53], s[0:1], 104
    s_load_dwordx2 s[24:25], s[0:1], 32
    s_load_dwordx2 s[28:29], s[0:1], 40
    s_load_dwordx2 s[32:33], s[0:1], 56
    s_load_dwordx2 s[36:37], s[0:1], 64
    s_load_dwordx2 s[48:49], s[0:1], 88
    s_getpc_b64 s[60:61]
L_pc:
    s_lshl_b32 s62, s2, 3
    v_add_u32 v4, s62, v0
    v_and_b32 v4, 255, v4
    v_cmp_le_u32 vcc, 192, v0
    v_lshlrev_b32 v4, 7, v4
    v_min_u32 v4, L_warm_ret-L_pc, v4
    v_mov_b32 v5, s61
    s_cbranch_vccz L_pf_skip
    v_add_co_u32 v4, vcc, s60, v4
    s_nop 1
    v_addc_co_u32 v5, vcc, 0, v5, vcc
    global_load_dword v253, v[4:5], off
L_pf_skip:
    v_lshrrev_b32 v2, 6, v0
    v_and_b32 v1, 63, v0
    s_mov_b32 s14, 2097152
    v_readfirstlane_b32 s5, v2
    s_mov_b32 s15, 0x00020000
    s_and_b32 s3, s2, 7
    s_lshr_b32 s4, s2, 3
    s_cmp_ge_u32 s5, 2
    s_cbranch_scc1 L_role_b
    s_lshl_b32 s60, s4, 16
    s_lshl_b32 s61, s3, 7
    s_add_u32 s60, s60, s61
    s_lshl_b32 s61, s5, 15
    s_add_u32 s60, s60, s61
    v_lshrrev_b32 v8, 4, v1
    v_and_b32 v9, 15, v1
    v_lshlrev_b32 v2, 13, v8
    v_lshl_add_u32 v2, v9, 3, v2
    v_add_u32 v2, s60, v2
    v_add_u32 v5, 4096, v2
    s_mov_b32 s18, s14
    s_mov_b32 s19, s15
    s_movk_i32 s22, 4096
    s_mov_b32 s23, s15
    v_subrev_u32 v3, 3072, v2
    s_lshl_b32 s62, s3, 9
    v_lshl_add_u32 v56, v9, 5, s62
    s_waitcnt lgkmcnt(0)
    buffer_load_dwordx2 v[10:11], v3, s[12:15], 0 offen offset:0 nt
    buffer_load_dwordx2 v[12:13], v3, s[12:15], 0 offen offset:1024 nt
    buffer_load_dwordx2 v[14:15], v3, s[12:15], 0 offen offset:2048 nt
    buffer_load_dwordx2 v[16:17], v2, s[12:15], 0 offen offset:0 nt
    buffer_load_dwordx2 v[18:19], v2, s[12:15], 0 offen offset:1024 nt
    buffer_load_dwordx2 v[20:21], v2, s[12:15], 0 offen offset:2048 nt
    buffer_load_dwordx2 v[22:23], v2, s[12:15], 0 offen offset:3072 nt
    buffer_load_dwordx2 v[24:25], v5, s[12:15], 0 offen offset:0 nt
    buffer_load_dwordx2 v[26:27], v5, s[12:15], 0 offen offset:1024 nt
    buffer_load_dwordx2 v[28:29], v5, s[12:15], 0 offen offset:2048 nt
    buffer_load_dwordx2 v[30:31], v5, s[12:15], 0 offen offset:3072 nt
    buffer_load_dwordx2 v[32:33], v2, s[16:19], 0 offen offset:0 nt
    buffer_load_dwordx2 v[34:35], v2, s[16:19], 0 offen offset:1024 nt
    buffer_load_dwordx2 v[36:37], v2, s[16:19], 0 offen offset:2048 nt
    buffer_load_dwordx2 v[38:39], v2, s[16:19], 0 offen offset:3072 nt
    buffer_load_dwordx2 v[40:41], v5, s[16:19], 0 offen offset:0 nt
    buffer_load_dwordx2 v[42:43], v5, s[16:19], 0 offen offset:1024 nt
    buffer_load_dwordx2 v[44:45], v5, s[16:19], 0 offen offset:2048 nt
    buffer_load_dwordx2 v[46:47], v5, s[16:19], 0 offen offset:3072 nt
    buffer_load_dwordx4 v[48:51], v56, s[20:23], 0 offen
    buffer_load_dwordx4 v[52:55], v56, s[20:23], 0 offen offset:16
    s_mov_b32 s54, 33554432
    s_mov_b32 s55, s15
    s_mov_b32 s26, s14
    s_mov_b32 s27, s15
    s_mov_b32 s10, s14
    s_mov_b32 s11, s15
    s_movk_i32 s30, 1024
    s_mov_b32 s31, s15
    s_mov_b32 s34, 1835008
    s_mov_b32 s35, s15
    s_mov_b32 s38, 1835008
    s_mov_b32 s39, s15
    s_mov_b32 s50, s14
    s_mov_b32 s51, s15
    v_mov_b32 v4, 29360128
    buffer_load_dwordx2 v[254:255], v4, s[52:55], 0 offen sc1
    s_lshl_b32 s60, s3, 18
    s_lshl_b32 s61, s4, 7
    s_sub_u32 s60, s60, s61
    s_lshl_b32 s61, s5, 6
    s_sub_u32 s60, s60, s61
    s_add_u32 s60, s60, 4032
    v_lshlrev_b32 v142, 14, v9
    v_add_u32 v142, s60, v142
    v_sub_u32 v56, 3, v8
    v_lshl_add_u32 v142, v56, 4, v142
    s_movk_i32 s64, 4096
    s_movk_i32 s65, 8192
    s_movk_i32 s66, 12288
    s_lshr_b32 s70, s4, 1
    s_lshl_b32 s60, s3, 4
    s_add_u32 s70, s70, s60
    s_and_b32 s69, s4, 1
    s_lshl_b32 s68, s70, 2
    s_add_u32 s68, s68, s5
    s_mov_b32 s71, s69
    s_sub_u32 s72, 3, s69
    s_lshl_b32 s60, s68, 12
    v_lshl_add_u32 v4, v1, 4, s60
    buffer_load_dwordx4 v[176:179], v4, s[24:27], 0 offen offset:0 nt
    buffer_load_dwordx2 v[180:181], v4, s[24:27], 0 offen offset:16 nt
    buffer_load_dwordx4 v[184:187], v4, s[24:27], 0 offen offset:1024 nt
    buffer_load_dwordx2 v[188:189], v4, s[24:27], 0 offen offset:1040 nt
    buffer_load_dwordx4 v[192:195], v4, s[24:27], 0 offen offset:2048 nt
    buffer_load_dwordx2 v[196:197], v4, s[24:27], 0 offen offset:2064 nt
    buffer_load_dwordx4 v[200:203], v4, s[24:27], 0 offen offset:3072 nt
    buffer_load_dwordx2 v[204:205], v4, s[24:27], 0 offen offset:3088 nt
    s_lshr_b32 s74, s3, 1
    s_lshl_b32 s74, s74, 2
    s_lshr_b32 s60, s4, 3
    s_add_u32 s74, s74, s60
    s_and_b32 s75, s3, 1
    s_lshl_b32 s75, s75, 3
    s_and_b32 s60, s4, 7
    s_add_u32 s75, s75, s60
    s_lshr_b32 s76, s4, 3
    s_lshl_b32 s60, s3, 2
    s_add_u32 s76, s76, s60
    s_and_b32 s77, s4, 7
    s_waitcnt vmcnt(8)
    v_readfirstlane_b32 s80, v254
    v_readfirstlane_b32 s81, v255
    s_add_u32 s80, s80, 0x9e3779b9
    s_add_u32 s81, s81, 0x7f4a7c15
    v_lshlrev_b32 v102, 16, v48
    v_lshlrev_b32 v103, 16, v50
    v_and_b32 v104, 0xffff0000, v48
    v_and_b32 v105, 0xffff0000, v50
    v_lshlrev_b32 v106, 16, v49
    v_lshlrev_b32 v107, 16, v51
    v_and_b32 v108, 0xffff0000, v49
    v_and_b32 v109, 0xffff0000, v51
    v_lshlrev_b32 v80, 16, v10
    v_and_b32 v81, 0xffff0000, v10
    v_lshlrev_b32 v82, 16, v12
    v_and_b32 v83, 0xffff0000, v12
    v_lshlrev_b32 v84, 16, v14
    v_and_b32 v85, 0xffff0000, v14
    v_lshlrev_b32 v86, 16, v16
    v_and_b32 v87, 0xffff0000, v16
    v_lshlrev_b32 v88, 16, v18
    v_and_b32 v89, 0xffff0000, v18
    v_lshlrev_b32 v90, 16, v20
    v_and_b32 v91, 0xffff0000, v20
    v_lshlrev_b32 v92, 16, v22
    v_and_b32 v93, 0xffff0000, v22
    v_lshlrev_b32 v94, 16, v24
    v_and_b32 v95, 0xffff0000, v24
    v_lshlrev_b32 v96, 16, v26
    v_and_b32 v97, 0xffff0000, v26
    v_lshlrev_b32 v98, 16, v28
    v_and_b32 v99, 0xffff0000, v28
    v_lshlrev_b32 v100, 16, v30
    v_and_b32 v101, 0xffff0000, v30
    v_lshlrev_b32 v126, 16, v32
    v_and_b32 v127, 0xffff0000, v32
    v_lshlrev_b32 v128, 16, v34
    v_and_b32 v129, 0xffff0000, v34
    v_lshlrev_b32 v130, 16, v36
    v_and_b32 v131, 0xffff0000, v36
    v_lshlrev_b32 v132, 16, v38
    v_and_b32 v133, 0xffff0000, v38
    v_lshlrev_b32 v134, 16, v40
    v_and_b32 v135, 0xffff0000, v40
    v_lshlrev_b32 v136, 16, v42
    v_and_b32 v137, 0xffff0000, v42
    v_lshlrev_b32 v138, 16, v44
    v_and_b32 v139, 0xffff0000, v44
    v_lshlrev_b32 v140, 16, v46
    v_and_b32 v141, 0xffff0000, v46
    v_pk_mul_f32 v[110:111], v[80:81], v[108:109]
    v_pk_mul_f32 v[112:113], v[82:83], v[108:109]
    v_pk_mul_f32 v[114:115], v[84:85], v[108:109]
    v_pk_mul_f32 v[116:117], v[86:87], v[108:109]
    v_pk_mul_f32 v[118:119], v[88:89], v[108:109]
    v_pk_mul_f32 v[120:121], v[90:91], v[108:109]
    v_pk_mul_f32 v[122:123], v[92:93], v[108:109]
    v_pk_mul_f32 v[124:125], v[94:95], v[108:109]
    v_pk_fma_f32 v[110:111], v[82:83], v[106:107], v[110:111]
    v_pk_fma_f32 v[112:113], v[84:85], v[106:107], v[112:113]
    v_pk_fma_f32 v[114:115], v[86:87], v[106:107], v[114:115]
    v_pk_fma_f32 v[116:117], v[88:89], v[106:107], v[116:117]
    v_pk_fma_f32 v[118:119], v[90:91], v[106:107], v[118:119]
    v_pk_fma_f32 v[120:121], v[92:93], v[106:107], v[120:121]
    v_pk_fma_f32 v[122:123], v[94:95], v[106:107], v[122:123]
    v_pk_fma_f32 v[124:125], v[96:97], v[106:107], v[124:125]
    v_pk_fma_f32 v[110:111], v[84:85], v[104:105], v[110:111]
    v_pk_fma_f32 v[112:113], v[86:87], v[104:105], v[112:113]
    v_pk_fma_f32 v[114:115], v[88:89], v[104:105], v[114:115]
    v_pk_fma_f32 v[116:117], v[90:91], v[104:105], v[116:117]
    v_pk_fma_f32 v[118:119], v[92:93], v[104:105], v[118:119]
    v_pk_fma_f32 v[120:121], v[94:95], v[104:105], v[120:121]
    v_pk_fma_f32 v[122:123], v[96:97], v[104:105], v[122:123]
    v_pk_fma_f32 v[124:125], v[98:99], v[104:105], v[124:125]
    v_pk_fma_f32 v[110:111], v[86:87], v[102:103], v[110:111]
    v_pk_fma_f32 v[112:113], v[88:89], v[102:103], v[112:113]
    v_pk_fma_f32 v[114:115], v[90:91], v[102:103], v[114:115]
    v_pk_fma_f32 v[116:117], v[92:93], v[102:103], v[116:117]
    v_pk_fma_f32 v[118:119], v[94:95], v[102:103], v[118:119]
    v_pk_fma_f32 v[120:121], v[96:97], v[102:103], v[120:121]
    v_pk_fma_f32 v[122:123], v[98:99], v[102:103], v[122:123]
    v_pk_fma_f32 v[124:125], v[100:101], v[102:103], v[124:125]
    v_pk_mul_f32 v[110:111], v[110:111], v[126:127]
    v_pk_mul_f32 v[112:113], v[112:113], v[128:129]
    v_pk_mul_f32 v[114:115], v[114:115], v[130:131]
    v_pk_mul_f32 v[116:117], v[116:117], v[132:133]
    v_pk_mul_f32 v[118:119], v[118:119], v[134:135]
    v_pk_mul_f32 v[120:121], v[120:121], v[136:137]
    v_pk_mul_f32 v[122:123], v[122:123], v[138:139]
    v_pk_mul_f32 v[124:125], v[124:125], v[140:141]
    v_cvt_pk_bf16_f32 v144, v124, v122
    v_cvt_pk_bf16_f32 v148, v125, v123
    v_cvt_pk_bf16_f32 v145, v120, v118
    v_cvt_pk_bf16_f32 v149, v121, v119
    v_cvt_pk_bf16_f32 v146, v116, v114
    v_cvt_pk_bf16_f32 v150, v117, v115
    v_cvt_pk_bf16_f32 v147, v112, v110
    v_cvt_pk_bf16_f32 v151, v113, v111
    buffer_store_dwordx4 v[144:147], v142, s[52:55], 0 offen sc1
    buffer_store_dwordx4 v[148:151], v142, s[52:55], s64 offen sc1
    v_lshlrev_b32 v102, 16, v52
    v_lshlrev_b32 v103, 16, v54
    v_and_b32 v104, 0xffff0000, v52
    v_and_b32 v105, 0xffff0000, v54
    v_lshlrev_b32 v106, 16, v53
    v_lshlrev_b32 v107, 16, v55
    v_and_b32 v108, 0xffff0000, v53
    v_and_b32 v109, 0xffff0000, v55
    v_lshlrev_b32 v80, 16, v11
    v_and_b32 v81, 0xffff0000, v11
    v_lshlrev_b32 v82, 16, v13
    v_and_b32 v83, 0xffff0000, v13
    v_lshlrev_b32 v84, 16, v15
    v_and_b32 v85, 0xffff0000, v15
    v_lshlrev_b32 v86, 16, v17
    v_and_b32 v87, 0xffff0000, v17
    v_lshlrev_b32 v88, 16, v19
    v_and_b32 v89, 0xffff0000, v19
    v_lshlrev_b32 v90, 16, v21
    v_and_b32 v91, 0xffff0000, v21
    v_lshlrev_b32 v92, 16, v23
    v_and_b32 v93, 0xffff0000, v23
    v_lshlrev_b32 v94, 16, v25
    v_and_b32 v95, 0xffff0000, v25
    v_lshlrev_b32 v96, 16, v27
    v_and_b32 v97, 0xffff0000, v27
    v_lshlrev_b32 v98, 16, v29
    v_and_b32 v99, 0xffff0000, v29
    v_lshlrev_b32 v100, 16, v31
    v_and_b32 v101, 0xffff0000, v31
    v_lshlrev_b32 v126, 16, v33
    v_and_b32 v127, 0xffff0000, v33
    v_lshlrev_b32 v128, 16, v35
    v_and_b32 v129, 0xffff0000, v35
    v_lshlrev_b32 v130, 16, v37
    v_and_b32 v131, 0xffff0000, v37
    v_lshlrev_b32 v132, 16, v39
    v_and_b32 v133, 0xffff0000, v39
    v_lshlrev_b32 v134, 16, v41
    v_and_b32 v135, 0xffff0000, v41
    v_lshlrev_b32 v136, 16, v43
    v_and_b32 v137, 0xffff0000, v43
    v_lshlrev_b32 v138, 16, v45
    v_and_b32 v139, 0xffff0000, v45
    v_lshlrev_b32 v140, 16, v47
    v_and_b32 v141, 0xffff0000, v47
    v_pk_mul_f32 v[110:111], v[80:81], v[108:109]
    v_pk_mul_f32 v[112:113], v[82:83], v[108:109]
    v_pk_mul_f32 v[114:115], v[84:85], v[108:109]
    v_pk_mul_f32 v[116:117], v[86:87], v[108:109]
    v_pk_mul_f32 v[118:119], v[88:89], v[108:109]
    v_pk_mul_f32 v[120:121], v[90:91], v[108:109]
    v_pk_mul_f32 v[122:123], v[92:93], v[108:109]
    v_pk_mul_f32 v[124:125], v[94:95], v[108:109]
    v_pk_fma_f32 v[110:111], v[82:83], v[106:107], v[110:111]
    v_pk_fma_f32 v[112:113], v[84:85], v[106:107], v[112:113]
    v_pk_fma_f32 v[114:115], v[86:87], v[106:107], v[114:115]
    v_pk_fma_f32 v[116:117], v[88:89], v[106:107], v[116:117]
    v_pk_fma_f32 v[118:119], v[90:91], v[106:107], v[118:119]
    v_pk_fma_f32 v[120:121], v[92:93], v[106:107], v[120:121]
    v_pk_fma_f32 v[122:123], v[94:95], v[106:107], v[122:123]
    v_pk_fma_f32 v[124:125], v[96:97], v[106:107], v[124:125]
    v_pk_fma_f32 v[110:111], v[84:85], v[104:105], v[110:111]
    v_pk_fma_f32 v[112:113], v[86:87], v[104:105], v[112:113]
    v_pk_fma_f32 v[114:115], v[88:89], v[104:105], v[114:115]
    v_pk_fma_f32 v[116:117], v[90:91], v[104:105], v[116:117]
    v_pk_fma_f32 v[118:119], v[92:93], v[104:105], v[118:119]
    v_pk_fma_f32 v[120:121], v[94:95], v[104:105], v[120:121]
    v_pk_fma_f32 v[122:123], v[96:97], v[104:105], v[122:123]
    v_pk_fma_f32 v[124:125], v[98:99], v[104:105], v[124:125]
    v_pk_fma_f32 v[110:111], v[86:87], v[102:103], v[110:111]
    v_pk_fma_f32 v[112:113], v[88:89], v[102:103], v[112:113]
    v_pk_fma_f32 v[114:115], v[90:91], v[102:103], v[114:115]
    v_pk_fma_f32 v[116:117], v[92:93], v[102:103], v[116:117]
    v_pk_fma_f32 v[118:119], v[94:95], v[102:103], v[118:119]
    v_pk_fma_f32 v[120:121], v[96:97], v[102:103], v[120:121]
    v_pk_fma_f32 v[122:123], v[98:99], v[102:103], v[122:123]
    v_pk_fma_f32 v[124:125], v[100:101], v[102:103], v[124:125]
    v_pk_mul_f32 v[110:111], v[110:111], v[126:127]
    v_pk_mul_f32 v[112:113], v[112:113], v[128:129]
    v_pk_mul_f32 v[114:115], v[114:115], v[130:131]
    v_pk_mul_f32 v[116:117], v[116:117], v[132:133]
    v_pk_mul_f32 v[118:119], v[118:119], v[134:135]
    v_pk_mul_f32 v[120:121], v[120:121], v[136:137]
    v_pk_mul_f32 v[122:123], v[122:123], v[138:139]
    v_pk_mul_f32 v[124:125], v[124:125], v[140:141]
    v_cvt_pk_bf16_f32 v152, v124, v122
    v_cvt_pk_bf16_f32 v156, v125, v123
    v_cvt_pk_bf16_f32 v153, v120, v118
    v_cvt_pk_bf16_f32 v157, v121, v119
    v_cvt_pk_bf16_f32 v154, v116, v114
    v_cvt_pk_bf16_f32 v158, v117, v115
    v_cvt_pk_bf16_f32 v155, v112, v110
    v_cvt_pk_bf16_f32 v159, v113, v111
    buffer_store_dwordx4 v[152:155], v142, s[52:55], s65 offen sc1
    buffer_store_dwordx4 v[156:159], v142, s[52:55], s66 offen sc1
    s_waitcnt vmcnt(4)
    s_branch L_join1
L_role_b:
    s_sub_u32 s6, s5, 2
    s_movk_i32 s42, 1024
    s_mov_b32 s43, s15
    s_mov_b32 s46, 3145728
    s_mov_b32 s47, s15
    s_mov_b32 s10, s14
    s_mov_b32 s11, s15
    s_mov_b32 s54, 33554432
    s_mov_b32 s55, s15
    s_mov_b32 s26, s14
    s_mov_b32 s27, s15
    s_movk_i32 s30, 1024
    s_mov_b32 s31, s15
    s_mov_b32 s34, 1835008
    s_mov_b32 s35, s15
    s_mov_b32 s38, 1835008
    s_mov_b32 s39, s15
    s_mov_b32 s50, s14
    s_mov_b32 s51, s15
    s_waitcnt lgkmcnt(0)
    v_mov_b32 v4, 29360128
    buffer_load_dwordx2 v[254:255], v4, s[52:55], 0 offen sc1
    v_min_u32 v4, 14, v1
    v_lshlrev_b32 v4, 21, v4
    v_add_u32 v4, 2097024, v4
    buffer_load_dword v248, v4, s[52:55], 0 offen
    v_mov_b32 v4, 0
    buffer_load_dword v251, v4, s[48:51], 0 offen
    buffer_load_dword v250, v4, s[32:35], 0 offen
    buffer_load_dword v249, v4, s[36:39], 0 offen
    v_lshrrev_b32 v8, 2, v1
    v_and_b32 v14, 3, v1
    s_and_b32 s60, s2, 3
    s_lshl_b32 s60, s60, 7
    v_lshl_add_u32 v2, v8, 3, s60
    v_lshlrev_b32 v3, 1, v2
    buffer_load_dwordx4 v[164:167], v3, s[40:43], 0 offen
    s_movk_i32 s61, 6144
    v_mul_lo_u32 v3, v2, s61
    v_lshl_add_u32 v3, v14, 4, v3
    s_lshr_b32 s60, s2, 2
    s_lshl_b32 s60, s60, 7
    s_lshl_b32 s61, s6, 6
    s_add_u32 s60, s60, s61
    s_cmp_ge_u32 s2, 192
    s_cselect_b32 s60, 0x40000000, s60
    buffer_load_dwordx4 v[16:19], v3, s[44:47], s60 offen nt
    s_add_u32 s60, s60, 6144
    buffer_load_dwordx4 v[20:23], v3, s[44:47], s60 offen nt
    s_add_u32 s60, s60, 6144
    buffer_load_dwordx4 v[24:27], v3, s[44:47], s60 offen nt
    s_add_u32 s60, s60, 6144
    buffer_load_dwordx4 v[28:31], v3, s[44:47], s60 offen nt
    s_add_u32 s60, s60, 6144
    buffer_load_dwordx4 v[32:35], v3, s[44:47], s60 offen nt
    s_add_u32 s60, s60, 6144
    buffer_load_dwordx4 v[36:39], v3, s[44:47], s60 offen nt
    s_add_u32 s60, s60, 6144
    buffer_load_dwordx4 v[40:43], v3, s[44:47], s60 offen nt
    s_add_u32 s60, s60, 6144
    buffer_load_dwordx4 v[44:47], v3, s[44:47], s60 offen nt
    s_lshl_b32 s60, s2, 13
    s_lshl_b32 s61, s6, 12
    s_add_u32 s60, s60, s61
    v_lshrrev_b32 v3, 4, v1
    v_lshlrev_b32 v3, 10, v3
    v_and_b32 v4, 15, v1
    v_lshl_add_u32 v3, v4, 4, v3
    buffer_load_dwordx4 v[48:51], v3, s[8:11], s60 offen offset:0
    buffer_load_dwordx4 v[52:55], v3, s[8:11], s60 offen offset:256
    buffer_load_dwordx4 v[56:59], v3, s[8:11], s60 offen offset:512
    buffer_load_dwordx4 v[60:63], v3, s[8:11], s60 offen offset:768
    s_lshr_b32 s70, s4, 1
    s_lshl_b32 s60, s3, 4
    s_add_u32 s70, s70, s60
    s_and_b32 s69, s4, 1
    s_lshl_b32 s68, s70, 2
    s_add_u32 s68, s68, s5
    s_mov_b32 s71, s69
    s_sub_u32 s72, 3, s69
    s_lshr_b32 s74, s3, 1
    s_lshl_b32 s74, s74, 2
    s_lshr_b32 s60, s4, 3
    s_add_u32 s74, s74, s60
    s_and_b32 s75, s3, 1
    s_lshl_b32 s75, s75, 3
    s_and_b32 s60, s4, 7
    s_add_u32 s75, s75, s60
    s_lshr_b32 s76, s4, 3
    s_lshl_b32 s60, s3, 2
    s_add_u32 s76, s76, s60
    s_and_b32 s77, s4, 7
    v_and_b32 v2, 15, v1
    v_lshrrev_b32 v3, 4, v1
    s_waitcnt vmcnt(12)
    v_readfirstlane_b32 s80, v254
    v_readfirstlane_b32 s81, v255
    s_add_u32 s80, s80, 0x9e3779b9
    s_add_u32 s81, s81, 0x7f4a7c15
    v_lshlrev_b32 v100, 16, v164
    v_and_b32 v101, 0xffff0000, v164
    v_lshlrev_b32 v102, 16, v165
    v_and_b32 v103, 0xffff0000, v165
    v_lshlrev_b32 v104, 16, v166
    v_and_b32 v105, 0xffff0000, v166
    v_lshlrev_b32 v106, 16, v167
    v_and_b32 v107, 0xffff0000, v167
    v_mul_f32 v108, 3216550459, v100
    v_mul_f32 v109, 3216550459, v101
    v_mul_f32 v110, 3216550459, v102
    v_mul_f32 v111, 3216550459, v103
    v_mul_f32 v112, 3216550459, v104
    v_mul_f32 v113, 3216550459, v105
    v_mul_f32 v114, 3216550459, v106
    v_mul_f32 v115, 3216550459, v107
    v_exp_f32 v108, v108
    v_exp_f32 v109, v109
    v_exp_f32 v110, v110
    v_exp_f32 v111, v111
    v_exp_f32 v112, v112
    v_exp_f32 v113, v113
    v_exp_f32 v114, v114
    v_exp_f32 v115, v115
    v_add_f32 v108, 1.0, v108
    v_add_f32 v109, 1.0, v109
    v_add_f32 v110, 1.0, v110
    v_add_f32 v111, 1.0, v111
    v_add_f32 v112, 1.0, v112
    v_add_f32 v113, 1.0, v113
    v_add_f32 v114, 1.0, v114
    v_add_f32 v115, 1.0, v115
    v_rcp_f32 v108, v108
    v_rcp_f32 v109, v109
    v_rcp_f32 v110, v110
    v_rcp_f32 v111, v111
    v_rcp_f32 v112, v112
    v_rcp_f32 v113, v113
    v_rcp_f32 v114, v114
    v_rcp_f32 v115, v115
    v_mul_f32 v108, v100, v108
    v_mul_f32 v109, v101, v109
    v_mul_f32 v110, v102, v110
    v_mul_f32 v111, v103, v111
    v_mul_f32 v112, v104, v112
    v_mul_f32 v113, v105, v113
    v_mul_f32 v114, v106, v114
    v_mul_f32 v115, v107, v115
    v_cvt_pk_bf16_f32 v100, v108, v109
    v_cvt_pk_bf16_f32 v101, v110, v111
    v_cvt_pk_bf16_f32 v102, v112, v113
    v_cvt_pk_bf16_f32 v103, v114, v115
    v_lshlrev_b32 v108, 16, v100
    v_and_b32 v109, 0xffff0000, v100
    v_lshlrev_b32 v110, 16, v101
    v_and_b32 v111, 0xffff0000, v101
    v_lshlrev_b32 v112, 16, v102
    v_and_b32 v113, 0xffff0000, v102
    v_lshlrev_b32 v114, 16, v103
    v_and_b32 v115, 0xffff0000, v103
    s_waitcnt vmcnt(4)
    s_lshl_b32 s60, s68, 12
    v_lshl_add_u32 v4, v1, 4, s60
    buffer_load_dwordx4 v[176:179], v4, s[24:27], 0 offen offset:0 nt
    buffer_load_dwordx2 v[180:181], v4, s[24:27], 0 offen offset:16 nt
    buffer_load_dwordx4 v[184:187], v4, s[24:27], 0 offen offset:1024 nt
    buffer_load_dwordx2 v[188:189], v4, s[24:27], 0 offen offset:1040 nt
    buffer_load_dwordx4 v[192:195], v4, s[24:27], 0 offen offset:2048 nt
    buffer_load_dwordx2 v[196:197], v4, s[24:27], 0 offen offset:2064 nt
    buffer_load_dwordx4 v[200:203], v4, s[24:27], 0 offen offset:3072 nt
    buffer_load_dwordx2 v[204:205], v4, s[24:27], 0 offen offset:3088 nt
    s_lshl_b32 s61, s2, 1
    s_and_b32 s60, s5, 1
    s_add_u32 s60, s60, s61
    s_lshr_b32 s20, s60, 3
    s_and_b32 s21, s60, 7
    s_mul_i32 s61, s20, 37
    s_lshr_b32 s61, s61, 8
    s_mul_i32 s62, s61, 7
    s_sub_u32 s62, s20, s62
    s_mul_i32 s61, s61, 224
    s_lshl_b32 s63, s62, 5
    s_add_u32 s22, s63, 16
    s_cmp_ge_u32 s62, 3
    s_cselect_b32 s63, s22, s63
    s_movk_i32 s22, 16384
    s_cmp_eq_u32 s62, 6
    s_cselect_b32 s63, 96, s63
    s_cselect_b32 s22, 114688, s22
    s_add_u32 s61, s61, s63
    s_lshl_b32 s61, s61, 10
    s_lshl_b32 s62, s21, 7
    s_add_u32 s61, s61, s62
    s_cmp_ge_u32 s60, 448
    s_cselect_b32 s23, 0x40000000, s61
    v_lshrrev_b32 v169, 2, v1
    v_lshlrev_b32 v169, 10, v169
    v_and_b32 v5, 3, v1
    v_lshl_add_u32 v169, v5, 4, v169
    s_lshl_b32 s61, s6, 12
    s_add_u32 s62, s23, s22
    s_add_u32 m0, s61, 153600
    s_nop 0
    buffer_load_dwordx4 v169, s[36:39], s23 offen offset:0 nt lds
    s_add_u32 m0, s61, 154624
    s_nop 0
    buffer_load_dwordx4 v169, s[36:39], s62 offen offset:0 nt lds
    s_add_u32 m0, s61, 155584
    s_nop 0
    buffer_load_dwordx4 v169, s[36:39], s23 offen offset:64 nt lds
    s_add_u32 m0, s61, 156608
    s_nop 0
    buffer_load_dwordx4 v169, s[36:39], s62 offen offset:64 nt lds
    v_lshlrev_b32 v116, 16, v16
    v_and_b32 v117, 0xffff0000, v16
    v_lshlrev_b32 v118, 16, v17
    v_and_b32 v119, 0xffff0000, v17
    v_lshlrev_b32 v120, 16, v18
    v_and_b32 v121, 0xffff0000, v18
    v_lshlrev_b32 v122, 16, v19
    v_and_b32 v123, 0xffff0000, v19
    v_pk_mul_f32 v[124:125], v[116:117], v[108:109] op_sel_hi:[1,0]
    v_pk_mul_f32 v[126:127], v[118:119], v[108:109] op_sel_hi:[1,0]
    v_pk_mul_f32 v[128:129], v[120:121], v[108:109] op_sel_hi:[1,0]
    v_pk_mul_f32 v[130:131], v[122:123], v[108:109] op_sel_hi:[1,0]
    v_lshlrev_b32 v116, 16, v20
    v_and_b32 v117, 0xffff0000, v20
    v_lshlrev_b32 v118, 16, v21
    v_and_b32 v119, 0xffff0000, v21
    v_lshlrev_b32 v120, 16, v22
    v_and_b32 v121, 0xffff0000, v22
    v_lshlrev_b32 v122, 16, v23
    v_and_b32 v123, 0xffff0000, v23
    v_pk_fma_f32 v[124:125], v[116:117], v[108:109], v[124:125] op_sel:[0,1,0] op_sel_hi:[1,1,1]
    v_pk_fma_f32 v[126:127], v[118:119], v[108:109], v[126:127] op_sel:[0,1,0] op_sel_hi:[1,1,1]
    v_pk_fma_f32 v[128:129], v[120:121], v[108:109], v[128:129] op_sel:[0,1,0] op_sel_hi:[1,1,1]
    v_pk_fma_f32 v[130:131], v[122:123], v[108:109], v[130:131] op_sel:[0,1,0] op_sel_hi:[1,1,1]
    v_lshlrev_b32 v116, 16, v24
    v_and_b32 v117, 0xffff0000, v24
    v_lshlrev_b32 v118, 16, v25
    v_and_b32 v119, 0xffff0000, v25
    v_lshlrev_b32 v120, 16, v26
    v_and_b32 v121, 0xffff0000, v26
    v_lshlrev_b32 v122, 16, v27
    v_and_b32 v123, 0xffff0000, v27
    v_pk_fma_f32 v[124:125], v[116:117], v[110:111], v[124:125] op_sel_hi:[1,0,1]
    v_pk_fma_f32 v[126:127], v[118:119], v[110:111], v[126:127] op_sel_hi:[1,0,1]
    v_pk_fma_f32 v[128:129], v[120:121], v[110:111], v[128:129] op_sel_hi:[1,0,1]
    v_pk_fma_f32 v[130:131], v[122:123], v[110:111], v[130:131] op_sel_hi:[1,0,1]
    v_lshlrev_b32 v116, 16, v28
    v_and_b32 v117, 0xffff0000, v28
    v_lshlrev_b32 v118, 16, v29
    v_and_b32 v119, 0xffff0000, v29
    v_lshlrev_b32 v120, 16, v30
    v_and_b32 v121, 0xffff0000, v30
    v_lshlrev_b32 v122, 16, v31
    v_and_b32 v123, 0xffff0000, v31
    v_pk_fma_f32 v[124:125], v[116:117], v[110:111], v[124:125] op_sel:[0,1,0] op_sel_hi:[1,1,1]
    v_pk_fma_f32 v[126:127], v[118:119], v[110:111], v[126:127] op_sel:[0,1,0] op_sel_hi:[1,1,1]
    v_pk_fma_f32 v[128:129], v[120:121], v[110:111], v[128:129] op_sel:[0,1,0] op_sel_hi:[1,1,1]
    v_pk_fma_f32 v[130:131], v[122:123], v[110:111], v[130:131] op_sel:[0,1,0] op_sel_hi:[1,1,1]
    v_lshlrev_b32 v116, 16, v32
    v_and_b32 v117, 0xffff0000, v32
    v_lshlrev_b32 v118, 16, v33
    v_and_b32 v119, 0xffff0000, v33
    v_lshlrev_b32 v120, 16, v34
    v_and_b32 v121, 0xffff0000, v34
    v_lshlrev_b32 v122, 16, v35
    v_and_b32 v123, 0xffff0000, v35
    v_pk_fma_f32 v[124:125], v[116:117], v[112:113], v[124:125] op_sel_hi:[1,0,1]
    v_pk_fma_f32 v[126:127], v[118:119], v[112:113], v[126:127] op_sel_hi:[1,0,1]
    v_pk_fma_f32 v[128:129], v[120:121], v[112:113], v[128:129] op_sel_hi:[1,0,1]
    v_pk_fma_f32 v[130:131], v[122:123], v[112:113], v[130:131] op_sel_hi:[1,0,1]
    v_lshlrev_b32 v116, 16, v36
    v_and_b32 v117, 0xffff0000, v36
    v_lshlrev_b32 v118, 16, v37
    v_and_b32 v119, 0xffff0000, v37
    v_lshlrev_b32 v120, 16, v38
    v_and_b32 v121, 0xffff0000, v38
    v_lshlrev_b32 v122, 16, v39
    v_and_b32 v123, 0xffff0000, v39
    v_pk_fma_f32 v[124:125], v[116:117], v[112:113], v[124:125] op_sel:[0,1,0] op_sel_hi:[1,1,1]
    v_pk_fma_f32 v[126:127], v[118:119], v[112:113], v[126:127] op_sel:[0,1,0] op_sel_hi:[1,1,1]
    v_pk_fma_f32 v[128:129], v[120:121], v[112:113], v[128:129] op_sel:[0,1,0] op_sel_hi:[1,1,1]
    v_pk_fma_f32 v[130:131], v[122:123], v[112:113], v[130:131] op_sel:[0,1,0] op_sel_hi:[1,1,1]
    v_lshlrev_b32 v116, 16, v40
    v_and_b32 v117, 0xffff0000, v40
    v_lshlrev_b32 v118, 16, v41
    v_and_b32 v119, 0xffff0000, v41
    v_lshlrev_b32 v120, 16, v42
    v_and_b32 v121, 0xffff0000, v42
    v_lshlrev_b32 v122, 16, v43
    v_and_b32 v123, 0xffff0000, v43
    v_pk_fma_f32 v[124:125], v[116:117], v[114:115], v[124:125] op_sel_hi:[1,0,1]
    v_pk_fma_f32 v[126:127], v[118:119], v[114:115], v[126:127] op_sel_hi:[1,0,1]
    v_pk_fma_f32 v[128:129], v[120:121], v[114:115], v[128:129] op_sel_hi:[1,0,1]
    v_pk_fma_f32 v[130:131], v[122:123], v[114:115], v[130:131] op_sel_hi:[1,0,1]
    v_lshlrev_b32 v116, 16, v44
    v_and_b32 v117, 0xffff0000, v44
    v_lshlrev_b32 v118, 16, v45
    v_and_b32 v119, 0xffff0000, v45
    v_lshlrev_b32 v120, 16, v46
    v_and_b32 v121, 0xffff0000, v46
    v_lshlrev_b32 v122, 16, v47
    v_and_b32 v123, 0xffff0000, v47
    v_pk_fma_f32 v[124:125], v[116:117], v[114:115], v[124:125] op_sel:[0,1,0] op_sel_hi:[1,1,1]
    v_pk_fma_f32 v[126:127], v[118:119], v[114:115], v[126:127] op_sel:[0,1,0] op_sel_hi:[1,1,1]
    v_pk_fma_f32 v[128:129], v[120:121], v[114:115], v[128:129] op_sel:[0,1,0] op_sel_hi:[1,1,1]
    v_pk_fma_f32 v[130:131], v[122:123], v[114:115], v[130:131] op_sel:[0,1,0] op_sel_hi:[1,1,1]
    v_add_f32_dpp v124, v124, v124 row_ror:4 row_mask:0xf bank_mask:0xf
    v_add_f32_dpp v125, v125, v125 row_ror:4 row_mask:0xf bank_mask:0xf
    v_add_f32_dpp v126, v126, v126 row_ror:4 row_mask:0xf bank_mask:0xf
    v_add_f32_dpp v127, v127, v127 row_ror:4 row_mask:0xf bank_mask:0xf
    v_add_f32_dpp v128, v128, v128 row_ror:4 row_mask:0xf bank_mask:0xf
    v_add_f32_dpp v129, v129, v129 row_ror:4 row_mask:0xf bank_mask:0xf
    v_add_f32_dpp v130, v130, v130 row_ror:4 row_mask:0xf bank_mask:0xf
    v_add_f32_dpp v131, v131, v131 row_ror:4 row_mask:0xf bank_mask:0xf
    v_add_f32_dpp v124, v124, v124 row_ror:8 row_mask:0xf bank_mask:0xf
    v_add_f32_dpp v125, v125, v125 row_ror:8 row_mask:0xf bank_mask:0xf
    v_add_f32_dpp v126, v126, v126 row_ror:8 row_mask:0xf bank_mask:0xf
    v_add_f32_dpp v127, v127, v127 row_ror:8 row_mask:0xf bank_mask:0xf
    v_add_f32_dpp v128, v128, v128 row_ror:8 row_mask:0xf bank_mask:0xf
    v_add_f32_dpp v129, v129, v129 row_ror:8 row_mask:0xf bank_mask:0xf
    v_add_f32_dpp v130, v130, v130 row_ror:8 row_mask:0xf bank_mask:0xf
    v_add_f32_dpp v131, v131, v131 row_ror:8 row_mask:0xf bank_mask:0xf
    s_lshl_b32 s60, s6, 9
    s_add_u32 s60, s60, 161792
    v_lshl_add_u32 v116, v3, 7, s60
    v_and_b32 v117, 3, v1
    v_lshl_add_u32 v116, v117, 5, v116
    ds_write_b128 v116, v[124:127]
    ds_write_b128 v116, v[128:131] offset:16
    v_and_b32 v117, 31, v1
    v_lshlrev_b32 v117, 2, v117
    v_add_u32 v116, s60, v117
    ds_read_b32 v120, v116
    ds_read_b32 v121, v116 offset:128
    ds_read_b32 v122, v116 offset:256
    ds_read_b32 v123, v116 offset:384
    s_waitcnt vmcnt(12)
    s_and_b32 s60, s2, 3
    s_mul_i32 s60, s60, 24576
    s_lshr_b32 s61, s2, 2
    s_lshl_b32 s61, s61, 9
    s_add_u32 s60, s60, s61
    s_lshl_b32 s61, s6, 8
    s_add_u32 s60, s60, s61
    s_add_u32 s60, s60, 16842752
    s_cmp_ge_u32 s2, 192
    s_cselect_b32 s60, 0x40000000, s60
    v_lshlrev_b32 v117, 1, v117
    s_waitcnt lgkmcnt(0)
    v_add_f32 v120, v120, v121
    v_add_f32 v122, v122, v123
    v_add_f32 v120, v120, v122
    v_mov_b32 v121, s80
    s_mov_b32 exec_hi, 0
    buffer_store_dwordx2 v[120:121], v117, s[52:55], s60 offen sc1
    s_mov_b32 exec_hi, -1
    v_lshlrev_b32 v100, 16, v48
    v_and_b32 v101, 0xffff0000, v48
    v_lshlrev_b32 v102, 16, v49
    v_and_b32 v103, 0xffff0000, v49
    v_lshlrev_b32 v104, 16, v50
    v_and_b32 v105, 0xffff0000, v50
    v_lshlrev_b32 v106, 16, v51
    v_and_b32 v107, 0xffff0000, v51
    v_lshlrev_b32 v108, 16, v52
    v_and_b32 v109, 0xffff0000, v52
    v_lshlrev_b32 v110, 16, v53
    v_and_b32 v111, 0xffff0000, v53
    v_lshlrev_b32 v112, 16, v54
    v_and_b32 v113, 0xffff0000, v54
    v_lshlrev_b32 v114, 16, v55
    v_and_b32 v115, 0xffff0000, v55
    v_lshlrev_b32 v116, 16, v56
    v_and_b32 v117, 0xffff0000, v56
    v_lshlrev_b32 v118, 16, v57
    v_and_b32 v119, 0xffff0000, v57
    v_lshlrev_b32 v120, 16, v58
    v_and_b32 v121, 0xffff0000, v58
    v_lshlrev_b32 v122, 16, v59
    v_and_b32 v123, 0xffff0000, v59
    v_lshlrev_b32 v124, 16, v60
    v_and_b32 v125, 0xffff0000, v60
    v_lshlrev_b32 v126, 16, v61
    v_and_b32 v127, 0xffff0000, v61
    v_lshlrev_b32 v128, 16, v62
    v_and_b32 v129, 0xffff0000, v62
    v_lshlrev_b32 v130, 16, v63
    v_and_b32 v131, 0xffff0000, v63
    v_pk_add_f32 v[132:133], v[100:101], v[102:103]
    v_pk_add_f32 v[134:135], v[104:105], v[106:107]
    v_pk_add_f32 v[136:137], v[108:109], v[110:111]
    v_pk_add_f32 v[138:139], v[112:113], v[114:115]
    v_pk_add_f32 v[140:141], v[116:117], v[118:119]
    v_pk_add_f32 v[142:143], v[120:121], v[122:123]
    v_pk_add_f32 v[144:145], v[124:125], v[126:127]
    v_pk_add_f32 v[146:147], v[128:129], v[130:131]
    v_pk_add_f32 v[132:133], v[132:133], v[140:141]
    v_pk_add_f32 v[134:135], v[134:135], v[142:143]
    v_pk_add_f32 v[136:137], v[136:137], v[144:145]
    v_pk_add_f32 v[138:139], v[138:139], v[146:147]
    v_pk_add_f32 v[132:133], v[132:133], v[136:137]
    v_pk_add_f32 v[134:135], v[134:135], v[138:139]
    v_pk_add_f32 v[132:133], v[132:133], v[134:135]
    v_add_f32 v132, v132, v133
    s_nop 1
    v_add_f32_dpp v132, v132, v132 row_ror:8 row_mask:0xf bank_mask:0xf
    s_nop 1
    v_add_f32_dpp v132, v132, v132 row_ror:4 row_mask:0xf bank_mask:0xf
    s_nop 1
    v_add_f32_dpp v132, v132, v132 row_ror:2 row_mask:0xf bank_mask:0xf
    s_nop 1
    v_add_f32_dpp v132, v132, v132 row_ror:1 row_mask:0xf bank_mask:0xf
    v_mul_f32 v148, 0xbb000000, v132
    v_pk_add_f32 v[100:101], v[100:101], v[148:149] op_sel_hi:[1,0]
    v_pk_add_f32 v[102:103], v[102:103], v[148:149] op_sel_hi:[1,0]
    v_pk_add_f32 v[104:105], v[104:105], v[148:149] op_sel_hi:[1,0]
    v_pk_add_f32 v[106:107], v[106:107], v[148:149] op_sel_hi:[1,0]
    v_pk_add_f32 v[108:109], v[108:109], v[148:149] op_sel_hi:[1,0]
    v_pk_add_f32 v[110:111], v[110:111], v[148:149] op_sel_hi:[1,0]
    v_pk_add_f32 v[112:113], v[112:113], v[148:149] op_sel_hi:[1,0]
    v_pk_add_f32 v[114:115], v[114:115], v[148:149] op_sel_hi:[1,0]
    v_pk_add_f32 v[116:117], v[116:117], v[148:149] op_sel_hi:[1,0]
    v_pk_add_f32 v[118:119], v[118:119], v[148:149] op_sel_hi:[1,0]
    v_pk_add_f32 v[120:121], v[120:121], v[148:149] op_sel_hi:[1,0]
    v_pk_add_f32 v[122:123], v[122:123], v[148:149] op_sel_hi:[1,0]
    v_pk_add_f32 v[124:125], v[124:125], v[148:149] op_sel_hi:[1,0]
    v_pk_add_f32 v[126:127], v[126:127], v[148:149] op_sel_hi:[1,0]
    v_pk_add_f32 v[128:129], v[128:129], v[148:149] op_sel_hi:[1,0]
    v_pk_add_f32 v[130:131], v[130:131], v[148:149] op_sel_hi:[1,0]
    v_pk_mul_f32 v[132:133], v[100:101], v[100:101]
    v_pk_mul_f32 v[134:135], v[102:103], v[102:103]
    v_pk_mul_f32 v[136:137], v[104:105], v[104:105]
    v_pk_mul_f32 v[138:139], v[106:107], v[106:107]
    v_pk_fma_f32 v[132:133], v[108:109], v[108:109], v[132:133]
    v_pk_fma_f32 v[134:135], v[110:111], v[110:111], v[134:135]
    v_pk_fma_f32 v[136:137], v[112:113], v[112:113], v[136:137]
    v_pk_fma_f32 v[138:139], v[114:115], v[114:115], v[138:139]
    v_pk_fma_f32 v[132:133], v[116:117], v[116:117], v[132:133]
    v_pk_fma_f32 v[134:135], v[118:119], v[118:119], v[134:135]
    v_pk_fma_f32 v[136:137], v[120:121], v[120:121], v[136:137]
    v_pk_fma_f32 v[138:139], v[122:123], v[122:123], v[138:139]
    v_pk_fma_f32 v[132:133], v[124:125], v[124:125], v[132:133]
    v_pk_fma_f32 v[134:135], v[126:127], v[126:127], v[134:135]
    v_pk_fma_f32 v[136:137], v[128:129], v[128:129], v[136:137]
    v_pk_fma_f32 v[138:139], v[130:131], v[130:131], v[138:139]
    v_pk_add_f32 v[132:133], v[132:133], v[134:135]
    v_pk_add_f32 v[136:137], v[136:137], v[138:139]
    v_pk_add_f32 v[132:133], v[132:133], v[136:137]
    v_add_f32 v132, v132, v133
    s_nop 1
    v_add_f32_dpp v132, v132, v132 row_ror:8 row_mask:0xf bank_mask:0xf
    s_nop 1
    v_add_f32_dpp v132, v132, v132 row_ror:4 row_mask:0xf bank_mask:0xf
    s_nop 1
    v_add_f32_dpp v132, v132, v132 row_ror:2 row_mask:0xf bank_mask:0xf
    s_nop 1
    v_add_f32_dpp v132, v132, v132 row_ror:1 row_mask:0xf bank_mask:0xf
    v_mov_b32 v133, 0x3727c5ac
    v_fmac_f32 v133, 0x3b000000, v132
    v_rsq_f32 v136, v133
    s_lshl_b32 s60, s2, 7
    s_lshl_b32 s61, s6, 6
    s_add_u32 s60, s60, s61
    s_add_u32 s60, s60, 16777216
    v_mov_b32 v137, s80
    v_mov_b32 v139, s80
    v_mul_f32 v138, v148, v136
    v_lshlrev_b32 v134, 4, v3
    s_mov_b32 exec_lo, 0x00010001
    s_mov_b32 exec_hi, 0x00010001
    buffer_store_dwordx4 v[136:139], v134, s[52:55], s60 offen sc1
    s_mov_b64 exec, -1
    s_waitcnt vmcnt(6)
L_join1:
    s_mul_i32 s60, s5, 16640
    s_add_u32 s60, s60, 32768
    v_lshl_add_u32 v4, v1, 4, s60
    v_mov_b32 v100, 0
    v_mov_b32 v101, 0
    v_mov_b32 v102, 0
    v_mov_b32 v103, 0
    s_mov_b64 s[62:63], exec
    s_mov_b64 exec, 15
    ds_write_b128 v4, v[100:103] offset:0
    ds_write_b128 v4, v[100:103] offset:4160
    ds_write_b128 v4, v[100:103] offset:8320
    ds_write_b128 v4, v[100:103] offset:12480
    s_mov_b64 exec, s[62:63]
    ds_write_b128 v4, v[176:179] offset:64
    v_alignbit_b32 v104, v177, v176, 16
    v_alignbit_b32 v105, v178, v177, 16
    v_alignbit_b32 v106, v179, v178, 16
    v_alignbit_b32 v107, v180, v179, 16
    v_mov_b32 v108, v177
    v_mov_b32 v109, v178
    v_mov_b32 v110, v179
    v_mov_b32 v111, v180
    v_alignbit_b32 v112, v178, v177, 16
    v_alignbit_b32 v113, v179, v178, 16
    v_alignbit_b32 v114, v180, v179, 16
    v_alignbit_b32 v115, v181, v180, 16
    ds_write_b128 v4, v[104:107] offset:4224
    ds_write_b128 v4, v[108:111] offset:8384
    ds_write_b128 v4, v[112:115] offset:12544
    v_lshlrev_b32 v128, 16, v176
    s_mov_b64 exec, 1
    ds_write_b32 v4, v128 offset:4220
    ds_write_b32 v4, v176 offset:8380
    ds_write_b32 v4, v128 offset:12536
    ds_write_b32 v4, v104 offset:12540
    s_mov_b64 exec, s[62:63]
    ds_write_b128 v4, v[184:187] offset:1088
    v_alignbit_b32 v116, v185, v184, 16
    v_alignbit_b32 v117, v186, v185, 16
    v_alignbit_b32 v118, v187, v186, 16
    v_alignbit_b32 v119, v188, v187, 16
    v_mov_b32 v120, v185
    v_mov_b32 v121, v186
    v_mov_b32 v122, v187
    v_mov_b32 v123, v188
    v_alignbit_b32 v124, v186, v185, 16
    v_alignbit_b32 v125, v187, v186, 16
    v_alignbit_b32 v126, v188, v187, 16
    v_alignbit_b32 v127, v189, v188, 16
    ds_write_b128 v4, v[116:119] offset:5248
    ds_write_b128 v4, v[120:123] offset:9408
    ds_write_b128 v4, v[124:127] offset:13568
    ds_write_b128 v4, v[192:195] offset:2112
    v_alignbit_b32 v104, v193, v192, 16
    v_alignbit_b32 v105, v194, v193, 16
    v_alignbit_b32 v106, v195, v194, 16
    v_alignbit_b32 v107, v196, v195, 16
    v_mov_b32 v108, v193
    v_mov_b32 v109, v194
    v_mov_b32 v110, v195
    v_mov_b32 v111, v196
    v_alignbit_b32 v112, v194, v193, 16
    v_alignbit_b32 v113, v195, v194, 16
    v_alignbit_b32 v114, v196, v195, 16
    v_alignbit_b32 v115, v197, v196, 16
    ds_write_b128 v4, v[104:107] offset:6272
    ds_write_b128 v4, v[108:111] offset:10432
    ds_write_b128 v4, v[112:115] offset:14592
    ds_write_b128 v4, v[200:203] offset:3136
    v_alignbit_b32 v116, v201, v200, 16
    v_alignbit_b32 v117, v202, v201, 16
    v_alignbit_b32 v118, v203, v202, 16
    v_alignbit_b32 v119, v204, v203, 16
    v_mov_b32 v120, v201
    v_mov_b32 v121, v202
    v_mov_b32 v122, v203
    v_mov_b32 v123, v204
    v_alignbit_b32 v124, v202, v201, 16
    v_alignbit_b32 v125, v203, v202, 16
    v_alignbit_b32 v126, v204, v203, 16
    v_alignbit_b32 v127, v205, v204, 16
    ds_write_b128 v4, v[116:119] offset:7296
    ds_write_b128 v4, v[120:123] offset:11456
    ds_write_b128 v4, v[124:127] offset:15616
    s_mul_i32 s73, s5, 7584
    s_add_u32 s73, s73, 1536
    v_and_b32 v2, 15, v1
    v_lshrrev_b32 v3, 4, v1
    v_lshl_add_u32 v4, v1, 4, s73
    v_mov_b32 v6, 0
    v_mov_b32 v7, 0
    v_mov_b32 v8, 0
    v_mov_b32 v9, 0
    v_add_u32 v5, 1, v2
    v_and_b32 v10, 3, v5
    v_mul_u32_u24 v10, 4160, v10
    v_and_b32 v5, 28, v5
    v_lshl_add_u32 v5, v5, 1, v10
    v_and_b32 v10, 1, v3
    v_lshl_add_u32 v5, v10, 4, v5
    s_mul_i32 s60, s5, 16640
    s_add_u32 s60, s60, 32768
    v_add_u32 v5, s60, v5
    v_lshrrev_b32 v10, 1, v3
    s_add_u32 s60, s71, 1
    s_lshl_b32 s60, s60, 9
    s_add_u32 s61, s72, 1
    s_lshl_b32 s61, s61, 9
    v_mad_u32_u24 v11, v10, s60, v5
    v_mad_u32_u24 v12, v10, s61, v5
    v_add_u32 v15, s60, v11
    v_subrev_u32 v12, s60, v12
    s_cmp_eq_u32 s69, 0
    s_cselect_b64 vcc, -1, 0
    v_cndmask_b32 v13, v11, v12, vcc
    ds_read_b64 a[0:1], v11 offset:0
    ds_read_b64 a[2:3], v11 offset:8
    ds_read_b64 a[4:5], v11 offset:32
    ds_read_b64 a[6:7], v11 offset:40
    ds_read_b64 a[8:9], v11 offset:64
    ds_read_b64 a[10:11], v11 offset:72
    ds_read_b64 a[12:13], v11 offset:96
    ds_read_b64 a[14:15], v11 offset:104
    ds_read_b64 a[16:17], v11 offset:128
    ds_read_b64 a[18:19], v11 offset:136
    ds_read_b64 a[20:21], v11 offset:160
    ds_read_b64 a[22:23], v11 offset:168
    ds_read_b64 a[24:25], v11 offset:192
    ds_read_b64 a[26:27], v11 offset:200
    ds_read_b64 a[28:29], v11 offset:224
    ds_read_b64 a[30:31], v11 offset:232
    ds_read_b64 a[32:33], v11 offset:256
    ds_read_b64 a[34:35], v11 offset:264
    ds_read_b64 a[36:37], v11 offset:288
    ds_read_b64 a[38:39], v11 offset:296
    s_cmp_ge_u32 s5, 2
    s_cbranch_scc1 L_mid_b
    s_waitcnt vmcnt(0)
    s_lshl_b32 s60, s3, 5
    s_add_u32 s60, s60, s4
    s_lshl_b32 s60, s60, 1
    s_add_u32 s60, s60, s5
    s_lshl_b32 s60, s60, 6
    s_add_u32 s60, s60, 17825792
    v_lshl_add_u32 v252, v1, 3, s60
    v_mov_b32 v250, s80
    v_mov_b32 v251, s81
    s_mov_b64 exec, 1
    buffer_store_dwordx2 v[250:251], v252, s[52:55], 0 offen sc1
    s_mov_b64 exec, -1
L_mid_b:
    ds_read_b64 a[40:41], v11 offset:320
    ds_read_b64 a[42:43], v11 offset:328
    ds_read_b64 a[44:45], v11 offset:352
    ds_read_b64 a[46:47], v11 offset:360
    ds_read_b64 a[48:49], v11 offset:384
    ds_read_b64 a[50:51], v11 offset:392
    ds_read_b64 a[52:53], v11 offset:416
    ds_read_b64 a[54:55], v11 offset:424
    ds_read_b64 a[56:57], v11 offset:448
    ds_read_b64 a[58:59], v11 offset:456
    ds_read_b64 a[60:61], v11 offset:480
    ds_read_b64 a[62:63], v11 offset:488
    ds_read_b64 a[64:65], v13 offset:512
    ds_read_b64 a[66:67], v13 offset:520
    ds_read_b64 a[68:69], v13 offset:544
    ds_read_b64 a[70:71], v13 offset:552
    ds_read_b64 a[72:73], v13 offset:576
    ds_read_b64 a[74:75], v13 offset:584
    ds_read_b64 a[76:77], v13 offset:608
    ds_read_b64 a[78:79], v13 offset:616
    ds_read_b64 a[80:81], v13 offset:640
    ds_read_b64 a[82:83], v13 offset:648
    ds_read_b64 a[84:85], v13 offset:672
    ds_read_b64 a[86:87], v13 offset:680
    ds_read_b64 a[88:89], v13 offset:704
    ds_read_b64 a[90:91], v13 offset:712
    ds_read_b64 a[92:93], v13 offset:736
    ds_read_b64 a[94:95], v13 offset:744
    ds_read_b64 a[96:97], v13 offset:768
    ds_read_b64 a[98:99], v13 offset:776
    ds_read_b64 a[100:101], v13 offset:800
    ds_read_b64 a[102:103], v13 offset:808
    ds_read_b64 a[104:105], v13 offset:832
    ds_read_b64 a[106:107], v13 offset:840
    ds_read_b64 a[108:109], v13 offset:864
    ds_read_b64 a[110:111], v13 offset:872
    ds_read_b64 a[112:113], v13 offset:896
    ds_read_b64 a[114:115], v13 offset:904
    ds_read_b64 a[116:117], v13 offset:928
    ds_read_b64 a[118:119], v13 offset:936
    ds_read_b64 a[120:121], v13 offset:960
    ds_read_b64 a[122:123], v13 offset:968
    ds_read_b64 a[124:125], v13 offset:992
    ds_read_b64 a[126:127], v13 offset:1000
    ds_read_b64 a[128:129], v12 offset:1024
    ds_read_b64 a[130:131], v12 offset:1032
    ds_read_b64 a[132:133], v12 offset:1056
    ds_read_b64 a[134:135], v12 offset:1064
    ds_read_b64 a[136:137], v12 offset:1088
    ds_read_b64 a[138:139], v12 offset:1096
    ds_read_b64 a[140:141], v12 offset:1120
    ds_read_b64 a[142:143], v12 offset:1128
    ds_read_b64 a[144:145], v12 offset:1152
    ds_read_b64 a[146:147], v12 offset:1160
    ds_read_b64 a[148:149], v12 offset:1184
    ds_read_b64 a[150:151], v12 offset:1192
    ds_read_b64 a[152:153], v12 offset:1216
    ds_read_b64 a[154:155], v12 offset:1224
    ds_read_b64 a[156:157], v12 offset:1248
    ds_read_b64 a[158:159], v12 offset:1256
    ds_read_b64 a[160:161], v12 offset:1280
    ds_read_b64 a[162:163], v12 offset:1288
    ds_read_b64 a[164:165], v12 offset:1312
    ds_read_b64 a[166:167], v12 offset:1320
    ds_read_b64 a[168:169], v12 offset:1344
    ds_read_b64 a[170:171], v12 offset:1352
    ds_read_b64 a[172:173], v12 offset:1376
    ds_read_b64 a[174:175], v12 offset:1384
    ds_read_b64 a[176:177], v12 offset:1408
    ds_read_b64 a[178:179], v12 offset:1416
    ds_read_b64 a[180:181], v12 offset:1440
    ds_read_b64 a[182:183], v12 offset:1448
    ds_read_b64 a[184:185], v12 offset:1472
    ds_read_b64 a[186:187], v12 offset:1480
    ds_read_b64 a[188:189], v12 offset:1504
    ds_read_b64 a[190:191], v12 offset:1512
    ds_read_b64 a[192:193], v12 offset:1536
    ds_read_b64 a[194:195], v12 offset:1544
    ds_read_b64 a[196:197], v12 offset:1568
    ds_read_b64 a[198:199], v12 offset:1576
    ds_read_b64 a[200:201], v12 offset:1600
    ds_read_b64 a[202:203], v12 offset:1608
    ds_read_b64 a[204:205], v12 offset:1632
    ds_read_b64 a[206:207], v12 offset:1640
    ds_read_b64 a[208:209], v12 offset:1664
    ds_read_b64 a[210:211], v12 offset:1672
    ds_read_b64 a[212:213], v12 offset:1696
    ds_read_b64 a[214:215], v12 offset:1704
    ds_read_b64 a[216:217], v12 offset:1728
    ds_read_b64 a[218:219], v12 offset:1736
    ds_read_b64 a[220:221], v12 offset:1760
    ds_read_b64 a[222:223], v12 offset:1768
    ds_read_b64 a[224:225], v12 offset:1792
    ds_read_b64 a[226:227], v12 offset:1800
    ds_read_b64 a[228:229], v12 offset:1824
    ds_read_b64 a[230:231], v12 offset:1832
    ds_read_b64 a[232:233], v12 offset:1856
    ds_read_b64 a[234:235], v12 offset:1864
    ds_read_b64 a[236:237], v12 offset:1888
    ds_read_b64 a[238:239], v12 offset:1896
    ds_read_b64 a[240:241], v12 offset:1920
    ds_read_b64 a[242:243], v12 offset:1928
    ds_read_b64 a[244:245], v12 offset:1952
    ds_read_b64 a[246:247], v12 offset:1960
    ds_read_b64 a[248:249], v12 offset:1984
    ds_read_b64 a[250:251], v12 offset:1992
    ds_read_b64 a[252:253], v12 offset:2016
    ds_read_b64 a[254:255], v12 offset:2024
    ds_read_b64 v[176:177], v12 offset:2048
    ds_read_b64 v[178:179], v12 offset:2056
    ds_read_b64 v[180:181], v12 offset:2080
    ds_read_b64 v[182:183], v12 offset:2088
    ds_read_b64 v[184:185], v12 offset:2112
    ds_read_b64 v[186:187], v12 offset:2120
    ds_read_b64 v[188:189], v12 offset:2144
    ds_read_b64 v[190:191], v12 offset:2152
    ds_read_b64 v[192:193], v12 offset:2176
    ds_read_b64 v[194:195], v12 offset:2184
    ds_read_b64 v[196:197], v12 offset:2208
    ds_read_b64 v[198:199], v12 offset:2216
    ds_read_b64 v[200:201], v12 offset:2240
    ds_read_b64 v[202:203], v12 offset:2248
    ds_read_b64 v[204:205], v12 offset:2272
    ds_read_b64 v[206:207], v12 offset:2280
    ds_read_b64 v[208:209], v12 offset:2304
    ds_read_b64 v[210:211], v12 offset:2312
    ds_read_b64 v[212:213], v12 offset:2336
    ds_read_b64 v[214:215], v12 offset:2344
    ds_read_b64 v[216:217], v12 offset:2368
    ds_read_b64 v[218:219], v12 offset:2376
    ds_read_b64 v[220:221], v12 offset:2400
    ds_read_b64 v[222:223], v12 offset:2408
    ds_read_b64 v[224:225], v12 offset:2432
    ds_read_b64 v[226:227], v12 offset:2440
    ds_read_b64 v[228:229], v12 offset:2464
    ds_read_b64 v[230:231], v12 offset:2472
    ds_read_b64 v[232:233], v12 offset:2496
    ds_read_b64 v[234:235], v12 offset:2504
    ds_read_b64 v[236:237], v12 offset:2528
    ds_read_b64 v[238:239], v12 offset:2536
    ds_read_b64 v[240:241], v12 offset:2560
    ds_read_b64 v[242:243], v12 offset:2568
    ds_read_b64 v[244:245], v15
    ds_read_b64 v[246:247], v15 offset:8
    ds_write_b128 v4, v[6:9] offset:6144
    s_mov_b64 exec, 67108863
    ds_write_b128 v4, v[6:9] offset:7168
    s_mov_b64 exec, -1
    v_sub_u32 v5, 63, v2
    v_mul_u32_u24 v5, 96, v5
    v_add_u32 v5, s73, v5
    s_mul_i32 s60, s71, 1536
    s_mul_i32 s61, s72, 1536
    v_subrev_u32 v156, s60, v5
    v_subrev_u32 v157, s61, v5
    v_and_b32 v6, 1, v3
    v_lshlrev_b32 v6, 4, v6
    v_lshrrev_b32 v7, 1, v3
    s_add_u32 s60, s71, 1
    s_mul_i32 s60, s60, 768
    s_add_u32 s61, s72, 1
    s_mul_i32 s61, s61, 768
    v_mad_u32_u24 v80, v7, s60, v156
    v_mad_u32_u24 v82, v7, s61, v157
    v_add_u32 v80, v80, v6
    v_add_u32 v82, v82, v6
    v_subrev_u32 v82, s60, v82
    s_cmp_eq_u32 s69, 0
    s_cselect_b64 vcc, -1, 0
    v_cndmask_b32 v81, v80, v82, vcc
    v_lshlrev_b32 v6, 3, v3
    v_sub_u32 v6, 24, v6
    v_add_u32 v156, v156, v6
    v_add_u32 v157, v157, v6
    s_cmp_ge_u32 s5, 2
    s_cbranch_scc1 L_role_b2
    s_mov_b32 s62, s5
    s_cmp_eq_u32 s62, 0
    s_cselect_b32 s60, s71, s72
    s_lshl_b32 s60, s60, 19
    s_lshr_b32 s61, s70, 1
    s_lshl_b32 s61, s61, 4
    s_add_u32 s60, s60, s61
    s_lshl_b32 s61, s62, 13
    v_lshlrev_b32 v5, 10, v1
    s_add_u32 m0, s61, 102400
    s_nop 0
    buffer_load_dwordx4 v5, s[8:11], s60 offen lds
    s_add_u32 s60, s60, 65536
    s_add_u32 m0, s61, 103424
    s_nop 0
    buffer_load_dwordx4 v5, s[8:11], s60 offen lds
    s_add_u32 s60, s60, 65536
    s_add_u32 m0, s61, 104448
    s_nop 0
    buffer_load_dwordx4 v5, s[8:11], s60 offen lds
    s_add_u32 s60, s60, 65536
    s_add_u32 m0, s61, 105472
    s_nop 0
    buffer_load_dwordx4 v5, s[8:11], s60 offen lds
    s_add_u32 s60, s60, 65536
    s_add_u32 m0, s61, 106496
    s_nop 0
    buffer_load_dwordx4 v5, s[8:11], s60 offen lds
    s_add_u32 s60, s60, 65536
    s_add_u32 m0, s61, 107520
    s_nop 0
    buffer_load_dwordx4 v5, s[8:11], s60 offen lds
    s_add_u32 s60, s60, 65536
    s_add_u32 m0, s61, 108544
    s_nop 0
    buffer_load_dwordx4 v5, s[8:11], s60 offen lds
    s_add_u32 s60, s60, 65536
    s_add_u32 m0, s61, 109568
    s_nop 0
    buffer_load_dwordx4 v5, s[8:11], s60 offen lds
    s_branch L_join2
L_role_b2:
    s_lshl_b32 s61, s6, 12
    s_add_u32 s60, s61, 153600
    v_lshrrev_b32 v10, 2, v1
    v_lshl_add_u32 v11, v3, 2, v10
    s_cmp_eq_u32 s22, 114688
    s_cselect_b64 vcc, -1, 0
    s_movk_i32 s61, 1024
    s_cselect_b32 s61, 256, s61
    v_cndmask_b32 v10, v10, v11, vcc
    v_lshlrev_b32 v10, 6, v10
    v_and_b32 v11, 3, v1
    v_lshl_add_u32 v10, v11, 4, v10
    v_add_u32 v10, s60, v10
    v_add_u32 v11, s61, v10
    v_lshlrev_b32 v12, 4, v1
    s_mul_i32 s63, s21, 56
    s_add_u32 s63, s63, s20
    s_lshl_b32 s63, s63, 12
    s_add_u32 s63, s63, 14680064
    s_cmp_ge_u32 s20, 56
    s_cselect_b32 s63, 0x40000000, s63
    s_waitcnt vmcnt(2)
    ds_read_b64_tr_b16 v[16:17], v10 offset:0
    ds_read_b64_tr_b16 v[18:19], v11 offset:0
    ds_read_b64_tr_b16 v[20:21], v10 offset:8
    ds_read_b64_tr_b16 v[22:23], v11 offset:8
    ds_read_b64_tr_b16 v[24:25], v10 offset:2048
    ds_read_b64_tr_b16 v[26:27], v11 offset:2048
    ds_read_b64_tr_b16 v[28:29], v10 offset:2056
    ds_read_b64_tr_b16 v[30:31], v11 offset:2056
    s_waitcnt lgkmcnt(0)
    buffer_store_dwordx4 v[16:19], v12, s[52:55], s63 offen offset:0 sc1
    buffer_store_dwordx4 v[20:23], v12, s[52:55], s63 offen offset:1024 sc1
    buffer_store_dwordx4 v[24:27], v12, s[52:55], s63 offen offset:2048 sc1
    buffer_store_dwordx4 v[28:31], v12, s[52:55], s63 offen offset:3072 sc1
L_join2:
    s_movk_i32 s60, 10923
    v_add_u32 v19, 0, v1
    v_mul_u32_u24 v20, s60, v19
    v_lshrrev_b32 v20, 16, v20
    v_mul_u32_u24 v21, 6, v20
    v_sub_u32 v19, v19, v21
    v_min_u32 v19, 3, v19
    v_lshlrev_b32 v19, 4, v19
    v_lshl_add_u32 v16, v20, 6, v19
    v_add_u32 v19, 64, v1
    v_mul_u32_u24 v20, s60, v19
    v_lshrrev_b32 v20, 16, v20
    v_mul_u32_u24 v21, 6, v20
    v_sub_u32 v19, v19, v21
    v_min_u32 v19, 3, v19
    v_lshlrev_b32 v19, 4, v19
    v_lshl_add_u32 v17, v20, 6, v19
    v_add_u32 v19, 128, v1
    v_mul_u32_u24 v20, s60, v19
    v_lshrrev_b32 v20, 16, v20
    v_mul_u32_u24 v21, 6, v20
    v_sub_u32 v19, v19, v21
    v_min_u32 v19, 3, v19
    v_lshlrev_b32 v19, 4, v19
    v_lshl_add_u32 v18, v20, 6, v19
    s_lshl_b32 s64, s68, 12
    s_add_u32 s64, s64, 0
    s_add_u32 s65, s64, 2048
    v_and_b32 v161, 3, v1
    s_movk_i32 s60, 24576
    v_mul_u32_u24 v161, s60, v161
    v_bfe_u32 v5, v1, 2, 2
    v_lshl_add_u32 v161, v5, 12, v161
    v_lshl_add_u32 v161, v3, 3, v161
    s_lshl_b32 s60, s70, 5
    s_add_u32 s60, s60, 16842752
    v_add_u32 v161, s60, v161
    s_mul_i32 s60, s5, 112
    s_add_u32 s60, s60, s77
    s_lshl_b32 s60, s60, 6
    s_add_u32 s60, s60, 18874368
    v_and_b32 v5, 15, v1
    v_min_u32 v5, 13, v5
    v_lshl_add_u32 v248, v5, 9, s60
    v_bfe_u32 v5, v1, 4, 1
    v_mul_u32_u24 v5, 0, v5
    v_add_u32 v248, v248, v5
    s_mul_i32 s79, s77, 56
    s_mul_i32 s61, s5, 14
    s_add_u32 s79, s79, s61
    s_lshl_b32 s79, s79, 12
    s_add_u32 s79, s79, 14680064
    s_add_u32 s97, s79, 57344
    s_lshl_b32 s18, s77, 1
    s_lshr_b32 s61, s4, 3
    s_mul_i32 s61, s61, 7
    s_lshr_b32 s61, s61, 1
    s_add_u32 s18, s18, s61
    s_mul_i32 s18, s18, 0
    s_cmp_ge_u32 s18, 14
    s_cselect_b32 s60, 14, 0
    s_sub_u32 s18, s18, s60
    s_lshl_b32 s18, s18, 12
    s_add_u32 s79, s79, s18
    v_lshlrev_b32 v9, 4, v1
    s_lshr_b32 s60, s2, 4
    s_lshl_b32 s60, s60, 8
    s_add_u32 s60, s60, 16855040
    v_lshl_add_u32 v172, v2, 4, s60
    v_and_b32 v5, 1, v3
    v_lshl_add_u32 v172, v5, 12, v172
    s_movk_i32 s12, 24576
    s_mov_b32 s13, 49152
    s_mov_b32 s14, 73728
    s_mul_i32 s60, s5, 7616
    s_add_u32 s60, s60, 1536
    v_mul_u32_u24 v150, 144, v3
    v_lshl_add_u32 v150, v2, 3, v150
    v_add_u32 v150, s60, v150
    s_lshr_b32 s60, s5, 1
    s_and_b32 s61, s5, 1
    s_mul_i32 s62, s60, 1152
    s_lshl_b32 s63, s61, 6
    s_add_u32 s62, s62, s63
    s_add_u32 s62, s62, 1536
    v_bfe_u32 v151, v1, 2, 2
    v_mul_u32_u24 v151, 7616, v151
    v_and_b32 v5, 3, v1
    v_mul_u32_u24 v5, 144, v5
    v_add3_u32 v151, v151, v5, s62
    v_lshl_add_u32 v151, v3, 3, v151
    s_lshl_b32 s60, s5, 12
    s_and_b32 s61, s70, 1
    s_lshl_b32 s61, s61, 3
    s_add_u32 s60, s60, s61
    s_add_u32 s60, s60, 102400
    v_lshl_add_u32 v152, v3, 5, v2
    v_lshl_add_u32 v152, v152, 4, s60
    s_cmp_lt_u32 s5, 2
    s_cselect_b32 s60, s71, s72
    s_lshl_b32 s60, s60, 4
    s_and_b32 s61, s5, 1
    s_lshl_b32 s61, s61, 3
    s_add_u32 s60, s60, s61
    s_lshl_b32 s66, s60, 15
    s_lshl_b32 s61, s70, 8
    s_add_u32 s66, s66, s61
    s_add_u32 s66, s66, 4194304
    s_add_u32 s67, s66, 131072
    v_lshlrev_b32 v153, 15, v3
    v_lshl_add_u32 v153, v2, 4, v153
    v_lshrrev_b32 v14, 2, v1
    v_lshlrev_b32 v15, 5, v14
    v_and_b32 v12, 3, v1
    v_lshl_add_u32 v15, v12, 3, v15
    s_lshl_b32 s61, s5, 11
    s_add_u32 s61, s61, 145408
    v_add_u32 v173, s61, v15
    v_and_b32 v10, 1, v3
    v_cvt_f32_u32 v11, v10
    v_xor_b32 v10, 1, v10
    v_lshlrev_b32 v10, 6, v10
    v_lshl_add_u32 v10, v2, 2, v10
    s_lshl_b32 s61, s5, 7
    v_add_u32 v10, s61, v10
    v_lshl_add_u32 v14, v3, 3, s61
    v_and_b32 v15, 1, v1
    v_lshl_add_u32 v15, v15, 6, v14
    v_and_b32 v13, 1, v1
    v_lshlrev_b32 v13, 9, v13
    v_lshl_add_u32 v13, v3, 4, v13
    s_and_b32 s40, s2, 15
    s_lshl_b32 s40, s40, 4
    s_lshr_b32 s61, s2, 4
    s_add_u32 s40, s40, s61
    s_lshl_b32 s42, s40, 10
    s_lshl_b32 s61, s5, 6
    s_add_u32 s42, s42, s61
    s_add_u32 s42, s42, 24117248
    s_mul_i32 s40, s40, 7168
    s_lshl_b32 s61, s5, 10
    s_add_u32 s40, s40, s61
    s_add_u32 s40, s40, 22020096
    s_add_u32 s41, s40, 4096
    s_cmp_eq_u32 s5, 3
    s_cselect_b32 s41, 0x40000000, s41
    s_cmp_lg_u32 s5, 0
    s_cbranch_scc1 L_u_nopoll
    s_lshl_b32 s60, s3, 12
    s_add_u32 s60, s60, 17825792
    v_lshl_add_u32 v4, v1, 6, s60
    s_mov_b32 s62, 0
L_poll_A:
    buffer_load_dwordx2 v[6:7], v4, s[52:55], 0 offen sc1
    s_waitcnt vmcnt(0)
L_poll_A_chk:
    v_cmp_ne_u64 vcc, s[80:81], v[6:7]
    s_add_u32 s62, s62, 1
    s_cbranch_vccz L_poll_A_ok
    s_cmp_gt_u32 s62, 4194304
    s_cbranch_scc1 L_poll_A_ok
    s_sleep 6
    s_branch L_poll_A
L_poll_A_ok:
L_u_nopoll:
    s_waitcnt lgkmcnt(0)
    s_barrier
    s_add_u32 m0, s73, 5120
    s_nop 0
    buffer_load_dwordx4 v18, s[52:55], s65 offen sc1 lds
    s_add_u32 m0, s73, 4096
    s_nop 0
    buffer_load_dwordx4 v17, s[52:55], s65 offen sc1 lds
    s_add_u32 m0, s73, 3072
    s_nop 0
    buffer_load_dwordx4 v16, s[52:55], s65 offen sc1 lds
    s_add_u32 m0, s73, 2048
    s_nop 0
    buffer_load_dwordx4 v18, s[52:55], s64 offen sc1 lds
    s_add_u32 m0, s73, 1024
    s_nop 0
    buffer_load_dwordx4 v17, s[52:55], s64 offen sc1 lds
    s_cmp_eq_u32 s69, 1
    s_cbranch_scc1 L_u_short
    s_add_u32 m0, s73, 0
    s_nop 0
    buffer_load_dwordx4 v16, s[52:55], s64 offen sc1 lds
L_u_short:
    v_lshrrev_b32 v5, 1, v1
    v_mul_u32_u24 v5, 3584, v5
    v_and_b32 v6, 1, v1
    v_lshl_add_u32 v5, v6, 4, v5
    s_and_b32 s60, s2, 15
    s_mul_i32 s60, s60, 224
    s_lshr_b32 s61, s2, 4
    s_mul_i32 s61, s61, 114688
    s_add_u32 s60, s60, s61
    s_lshl_b32 s61, s5, 5
    s_add_u32 s60, s60, s61
    s_lshl_b32 s61, s5, 11
    s_add_u32 m0, s61, 145408
    s_nop 0
    buffer_load_dwordx4 v5, s[32:35], s60 offen lds
    s_add_u32 m0, s61, 146304
    s_nop 0
    buffer_load_dwordx4 v5, s[32:35], s60 offen offset:128 lds
    s_cmp_lt_u32 s5, 2
    s_cselect_b32 s60, s71, s72
    s_lshl_b32 s60, s60, 4
    s_and_b32 s61, s5, 1
    s_lshl_b32 s61, s61, 3
    s_add_u32 s43, s60, s61
    s_lshl_b32 s60, s43, 5
    v_lshl_add_u32 v5, v3, 5, v2
    v_add_u32 v5, s60, v5
    v_lshlrev_b32 v159, 4, v5
    v_add_u32 v159, 16777216, v159
    s_lshl_b32 s60, s68, 1
    v_mov_b32 v5, s60
    buffer_load_ushort v126, v5, s[28:31], 0 offen
    s_waitcnt vmcnt(3)
    ds_read_b128 v[48:51], v80 offset:0
    ds_read_b128 v[52:55], v80 offset:32
    ds_read_b128 v[56:59], v80 offset:96
    ds_read_b128 v[60:63], v80 offset:128
    ds_read_b128 v[64:67], v80 offset:192
    ds_read_b128 v[68:71], v80 offset:224
    ds_read_b128 v[72:75], v80 offset:288
    s_waitcnt lgkmcnt(6)
    v_mfma_f32_16x16x32_bf16 v[84:87], a[0:3], v[48:51], 0
    v_mfma_f32_16x16x32_bf16 v[88:91], a[4:7], v[48:51], 0
    ds_read_b128 v[76:79], v80 offset:320
    s_waitcnt lgkmcnt(6)
    v_mfma_f32_16x16x32_bf16 v[84:87], a[4:7], v[52:55], v[84:87]
    v_mfma_f32_16x16x32_bf16 v[88:91], a[8:11], v[52:55], v[88:91]
    s_cmp_lt_u32 s5, 2
    s_cbranch_scc1 L_skip_m
    s_waitcnt vmcnt(8)
    s_lshl_b32 s60, s2, 1
    s_add_u32 s60, s60, s6
    s_lshl_b32 s60, s60, 6
    s_add_u32 s60, s60, 18874368
    v_lshl_add_u32 v252, v1, 15, s60
    v_mov_b32 v250, s80
    v_mov_b32 v251, s81
    s_mov_b64 exec, 1
    buffer_store_dwordx2 v[250:251], v252, s[52:55], 0 offen sc1
    s_mov_b64 exec, -1
L_skip_m:
    ds_read_b128 v[48:51], v80 offset:384
    s_waitcnt lgkmcnt(6)
    v_mfma_f32_16x16x32_bf16 v[84:87], a[8:11], v[56:59], v[84:87]
    v_mfma_f32_16x16x32_bf16 v[88:91], a[12:15], v[56:59], v[88:91]
    buffer_load_dwordx4 v[32:35], v172, s[52:55], 0 offen sc1
    ds_read_b128 v[52:55], v80 offset:416
    s_waitcnt lgkmcnt(6)
    v_mfma_f32_16x16x32_bf16 v[84:87], a[12:15], v[60:63], v[84:87]
    v_mfma_f32_16x16x32_bf16 v[88:91], a[16:19], v[60:63], v[88:91]
    ds_read_b128 v[56:59], v80 offset:480
    s_waitcnt lgkmcnt(6)
    v_mfma_f32_16x16x32_bf16 v[84:87], a[16:19], v[64:67], v[84:87]
    v_mfma_f32_16x16x32_bf16 v[88:91], a[20:23], v[64:67], v[88:91]
    buffer_load_dwordx4 v[36:39], v172, s[52:55], s12 offen sc1
    ds_read_b128 v[60:63], v80 offset:512
    s_waitcnt lgkmcnt(6)
    v_mfma_f32_16x16x32_bf16 v[84:87], a[20:23], v[68:71], v[84:87]
    v_mfma_f32_16x16x32_bf16 v[88:91], a[24:27], v[68:71], v[88:91]
    ds_read_b128 v[64:67], v80 offset:576
    s_waitcnt lgkmcnt(6)
    v_mfma_f32_16x16x32_bf16 v[84:87], a[24:27], v[72:75], v[84:87]
    v_mfma_f32_16x16x32_bf16 v[88:91], a[28:31], v[72:75], v[88:91]
    buffer_load_dwordx4 v[40:43], v172, s[52:55], s13 offen sc1
    ds_read_b128 v[68:71], v80 offset:608
    s_waitcnt lgkmcnt(6)
    v_mfma_f32_16x16x32_bf16 v[84:87], a[28:31], v[76:79], v[84:87]
    v_mfma_f32_16x16x32_bf16 v[88:91], a[32:35], v[76:79], v[88:91]
    ds_read_b128 v[72:75], v80 offset:672
    s_waitcnt lgkmcnt(6)
    v_mfma_f32_16x16x32_bf16 v[84:87], a[32:35], v[48:51], v[84:87]
    v_mfma_f32_16x16x32_bf16 v[88:91], a[36:39], v[48:51], v[88:91]
    buffer_load_dwordx4 v[44:47], v172, s[52:55], s14 offen sc1
    ds_read_b128 v[76:79], v80 offset:704
    s_waitcnt lgkmcnt(6)
    v_mfma_f32_16x16x32_bf16 v[84:87], a[36:39], v[52:55], v[84:87]
    v_mfma_f32_16x16x32_bf16 v[88:91], a[40:43], v[52:55], v[88:91]
    ds_read_b128 v[48:51], v81 offset:768
    s_waitcnt lgkmcnt(6)
    v_mfma_f32_16x16x32_bf16 v[84:87], a[40:43], v[56:59], v[84:87]
    v_mfma_f32_16x16x32_bf16 v[88:91], a[44:47], v[56:59], v[88:91]
    ds_read_b128 v[52:55], v81 offset:800
    s_waitcnt lgkmcnt(6)
    v_mfma_f32_16x16x32_bf16 v[84:87], a[44:47], v[60:63], v[84:87]
    v_mfma_f32_16x16x32_bf16 v[88:91], a[48:51], v[60:63], v[88:91]
    ds_read_b128 v[56:59], v81 offset:864
    s_waitcnt lgkmcnt(6)
    v_mfma_f32_16x16x32_bf16 v[84:87], a[48:51], v[64:67], v[84:87]
    v_mfma_f32_16x16x32_bf16 v[88:91], a[52:55], v[64:67], v[88:91]
    ds_read_b128 v[60:63], v81 offset:896
    s_waitcnt lgkmcnt(6)
    v_mfma_f32_16x16x32_bf16 v[84:87], a[52:55], v[68:71], v[84:87]
    v_mfma_f32_16x16x32_bf16 v[88:91], a[56:59], v[68:71], v[88:91]
    ds_read_b128 v[64:67], v81 offset:960
    s_waitcnt lgkmcnt(6)
    v_mfma_f32_16x16x32_bf16 v[84:87], a[56:59], v[72:75], v[84:87]
    v_mfma_f32_16x16x32_bf16 v[88:91], a[60:63], v[72:75], v[88:91]
    s_cmp_eq_u32 s69, 0
    s_cbranch_scc0 L_cb15_no
    ds_read_b128 v[68:71], v81 offset:992
    s_waitcnt lgkmcnt(6)
    v_mfma_f32_16x16x32_bf16 v[92:95], a[60:63], v[76:79], v[84:87]
    v_mfma_f32_16x16x32_bf16 v[96:99], v[244:247], v[76:79], v[88:91]
    ds_read_b128 v[72:75], v81 offset:1056
    s_waitcnt lgkmcnt(6)
    v_mfma_f32_16x16x32_bf16 v[84:87], a[64:67], v[48:51], 0
    v_mfma_f32_16x16x32_bf16 v[88:91], a[68:71], v[48:51], 0
    s_branch L_cb15_done
L_cb15_no:
    ds_read_b128 v[68:71], v81 offset:992
    s_waitcnt lgkmcnt(6)
    v_mfma_f32_16x16x32_bf16 v[84:87], a[60:63], v[76:79], v[84:87]
    v_mfma_f32_16x16x32_bf16 v[88:91], a[64:67], v[76:79], v[88:91]
    ds_read_b128 v[72:75], v81 offset:1056
    s_waitcnt lgkmcnt(6)
    v_mfma_f32_16x16x32_bf16 v[84:87], a[64:67], v[48:51], v[84:87]
    v_mfma_f32_16x16x32_bf16 v[88:91], a[68:71], v[48:51], v[88:91]
L_cb15_done:
    ds_read_b128 v[76:79], v81 offset:1088
    s_waitcnt lgkmcnt(6)
    v_mfma_f32_16x16x32_bf16 v[84:87], a[68:71], v[52:55], v[84:87]
    v_mfma_f32_16x16x32_bf16 v[88:91], a[72:75], v[52:55], v[88:91]
    ds_read_b128 v[48:51], v81 offset:1152
    s_waitcnt lgkmcnt(6)
    v_mfma_f32_16x16x32_bf16 v[84:87], a[72:75], v[56:59], v[84:87]
    v_mfma_f32_16x16x32_bf16 v[88:91], a[76:79], v[56:59], v[88:91]
    ds_read_b128 v[52:55], v81 offset:1184
    s_waitcnt lgkmcnt(6)
    v_mfma_f32_16x16x32_bf16 v[84:87], a[76:79], v[60:63], v[84:87]
    v_mfma_f32_16x16x32_bf16 v[88:91], a[80:83], v[60:63], v[88:91]
    ds_read_b128 v[56:59], v81 offset:1248
    s_waitcnt lgkmcnt(6)
    v_mfma_f32_16x16x32_bf16 v[84:87], a[80:83], v[64:67], v[84:87]
    v_mfma_f32_16x16x32_bf16 v[88:91], a[84:87], v[64:67], v[88:91]
    ds_read_b128 v[60:63], v81 offset:1280
    s_waitcnt lgkmcnt(6)
    v_mfma_f32_16x16x32_bf16 v[84:87], a[84:87], v[68:71], v[84:87]
    v_mfma_f32_16x16x32_bf16 v[88:91], a[88:91], v[68:71], v[88:91]
    ds_read_b128 v[64:67], v81 offset:1344
    s_waitcnt lgkmcnt(6)
    v_mfma_f32_16x16x32_bf16 v[84:87], a[88:91], v[72:75], v[84:87]
    v_mfma_f32_16x16x32_bf16 v[88:91], a[92:95], v[72:75], v[88:91]
    buffer_load_dwordx2 v[124:125], v161, s[52:55], 0 offen sc1
    ds_read_b128 v[68:71], v81 offset:1376
    s_waitcnt lgkmcnt(6)
    v_mfma_f32_16x16x32_bf16 v[84:87], a[92:95], v[76:79], v[84:87]
    v_mfma_f32_16x16x32_bf16 v[88:91], a[96:99], v[76:79], v[88:91]
    ds_read_b128 v[72:75], v81 offset:1440
    s_waitcnt lgkmcnt(6)
    v_mfma_f32_16x16x32_bf16 v[84:87], a[96:99], v[48:51], v[84:87]
    v_mfma_f32_16x16x32_bf16 v[88:91], a[100:103], v[48:51], v[88:91]
    buffer_load_dwordx4 v[108:111], v159, s[52:55], 0 offen offset:0 sc1
    s_waitcnt vmcnt(2)
    ds_read_b64_tr_b16 v[16:17], v173
    ds_read_b64_tr_b16 v[18:19], v173 offset:512
    ds_read_b128 v[76:79], v81 offset:1472
    s_waitcnt lgkmcnt(6)
    v_mfma_f32_16x16x32_bf16 v[84:87], a[100:103], v[52:55], v[84:87]
    v_mfma_f32_16x16x32_bf16 v[88:91], a[104:107], v[52:55], v[88:91]
    ds_read_b64_tr_b16 v[20:21], v173 offset:1024
    ds_read_b64_tr_b16 v[22:23], v173 offset:1536
    s_mov_b32 s62, 0
L_ver_w:
    v_max3_u32 v24, v33, v35, v37
    v_max3_u32 v24, v24, v39, v41
    v_max3_u32 v24, v24, v43, v45
    v_max_u32 v24, v24, v47
    v_min3_u32 v25, v33, v35, v37
    v_min3_u32 v25, v25, v39, v41
    v_min3_u32 v25, v25, v43, v45
    v_min_u32 v25, v25, v47
    v_cmp_ne_u32 vcc, s80, v24
    v_cmp_ne_u32 s[60:61], s80, v25
    s_nop 0
    s_or_b64 vcc, vcc, s[60:61]
    s_cbranch_vccz L_ver_w_ok
    s_add_u32 s62, s62, 1
    s_cmp_gt_u32 s62, 4194304
    s_cbranch_scc1 L_ver_w_ok
    buffer_load_dwordx4 v[32:35], v172, s[52:55], 0 offen sc1
    buffer_load_dwordx4 v[36:39], v172, s[52:55], s12 offen sc1
    buffer_load_dwordx4 v[40:43], v172, s[52:55], s13 offen sc1
    buffer_load_dwordx4 v[44:47], v172, s[52:55], s14 offen sc1
    s_waitcnt vmcnt(0)
    s_branch L_ver_w
L_ver_w_ok:
    ds_read_b128 v[48:51], v82 offset:1536
    s_waitcnt lgkmcnt(6)
    v_mfma_f32_16x16x32_bf16 v[84:87], a[104:107], v[56:59], v[84:87]
    v_mfma_f32_16x16x32_bf16 v[88:91], a[108:111], v[56:59], v[88:91]
    buffer_load_dwordx4 v[112:115], v159, s[52:55], 0 offen offset:256 sc1
    v_add_f32 v32, v32, v36
    v_add_f32 v40, v40, v44
    v_add_f32 v34, v34, v38
    ds_read_b128 v[52:55], v82 offset:1568
    s_waitcnt lgkmcnt(6)
    v_mfma_f32_16x16x32_bf16 v[84:87], a[108:111], v[60:63], v[84:87]
    v_mfma_f32_16x16x32_bf16 v[88:91], a[112:115], v[60:63], v[88:91]
    v_add_f32 v42, v42, v46
    v_add_f32 v32, v32, v40
    v_add_f32 v34, v34, v42
    ds_read_b128 v[56:59], v82 offset:1632
    s_waitcnt lgkmcnt(6)
    v_mfma_f32_16x16x32_bf16 v[84:87], a[112:115], v[64:67], v[84:87]
    v_mfma_f32_16x16x32_bf16 v[88:91], a[116:119], v[64:67], v[88:91]
    buffer_load_dwordx4 v[116:119], v159, s[52:55], 0 offen offset:2048 sc1
    v_cvt_pk_bf16_f32 v32, v32, v34
    v_lshlrev_b32 v36, 16, v32
    v_and_b32 v37, 0xffff0000, v32
    ds_read_b128 v[60:63], v82 offset:1664
    s_waitcnt lgkmcnt(6)
    v_mfma_f32_16x16x32_bf16 v[84:87], a[116:119], v[68:71], v[84:87]
    v_mfma_f32_16x16x32_bf16 v[88:91], a[120:123], v[68:71], v[88:91]
    v_add_f32 v36, v11, v36
    v_add_f32 v37, v11, v37
    v_cvt_pk_bf16_f32 v32, v36, v37
    ds_read_b128 v[64:67], v82 offset:1728
    s_waitcnt lgkmcnt(6)
    v_mfma_f32_16x16x32_bf16 v[84:87], a[120:123], v[72:75], v[84:87]
    v_mfma_f32_16x16x32_bf16 v[88:91], a[124:127], v[72:75], v[88:91]
    buffer_load_dwordx4 v[120:123], v159, s[52:55], 0 offen offset:2304 sc1
    ds_write_b32 v10, v32
    ds_read_b64 v[24:25], v15
    ds_read_b64 v[26:27], v15 offset:32
    s_cmp_eq_u32 s69, 1
    s_cbranch_scc0 L_cb31_no
    ds_read_b128 v[68:71], v82 offset:1760
    s_waitcnt lgkmcnt(6)
    v_mfma_f32_16x16x32_bf16 v[92:95], a[124:127], v[76:79], v[84:87]
    v_mfma_f32_16x16x32_bf16 v[96:99], v[244:247], v[76:79], v[88:91]
    ds_read_b128 v[72:75], v82 offset:1824
    s_waitcnt lgkmcnt(6)
    v_mfma_f32_16x16x32_bf16 v[84:87], a[128:131], v[48:51], 0
    v_mfma_f32_16x16x32_bf16 v[88:91], a[132:135], v[48:51], 0
    s_branch L_cb31_done
L_cb31_no:
    ds_read_b128 v[68:71], v82 offset:1760
    s_waitcnt lgkmcnt(6)
    v_mfma_f32_16x16x32_bf16 v[84:87], a[124:127], v[76:79], v[84:87]
    v_mfma_f32_16x16x32_bf16 v[88:91], a[128:131], v[76:79], v[88:91]
    ds_read_b128 v[72:75], v82 offset:1824
    s_waitcnt lgkmcnt(6)
    v_mfma_f32_16x16x32_bf16 v[84:87], a[128:131], v[48:51], v[84:87]
    v_mfma_f32_16x16x32_bf16 v[88:91], a[132:135], v[48:51], v[88:91]
L_cb31_done:
    ds_read_b64 v[28:29], v14
    ds_read_b64 v[30:31], v14 offset:32
    buffer_load_dwordx2 v[252:253], v248, s[52:55], 0 offen sc1
    ds_read_b128 v[76:79], v82 offset:1856
    s_waitcnt lgkmcnt(6)
    v_mfma_f32_16x16x32_bf16 v[84:87], a[132:135], v[52:55], v[84:87]
    v_mfma_f32_16x16x32_bf16 v[88:91], a[136:139], v[52:55], v[88:91]
    ds_read_b128 v[48:51], v82 offset:1920
    s_waitcnt lgkmcnt(6)
    v_mfma_f32_16x16x32_bf16 v[84:87], a[136:139], v[56:59], v[84:87]
    v_mfma_f32_16x16x32_bf16 v[88:91], a[140:143], v[56:59], v[88:91]
    ds_read_b128 v[52:55], v82 offset:1952
    s_waitcnt lgkmcnt(6)
    v_mfma_f32_16x16x32_bf16 v[84:87], a[140:143], v[60:63], v[84:87]
    v_mfma_f32_16x16x32_bf16 v[88:91], a[144:147], v[60:63], v[88:91]
    ds_read_b128 v[56:59], v82 offset:2016
    s_waitcnt lgkmcnt(6)
    v_mfma_f32_16x16x32_bf16 v[84:87], a[144:147], v[64:67], v[84:87]
    v_mfma_f32_16x16x32_bf16 v[88:91], a[148:151], v[64:67], v[88:91]
    ds_read_b128 v[60:63], v82 offset:2048
    s_waitcnt lgkmcnt(6)
    v_mfma_f32_16x16x32_bf16 v[84:87], a[148:151], v[68:71], v[84:87]
    v_mfma_f32_16x16x32_bf16 v[88:91], a[152:155], v[68:71], v[88:91]
    ds_read_b128 v[64:67], v82 offset:2112
    s_waitcnt lgkmcnt(6)
    v_mfma_f32_16x16x32_bf16 v[84:87], a[152:155], v[72:75], v[84:87]
    v_mfma_f32_16x16x32_bf16 v[88:91], a[156:159], v[72:75], v[88:91]
    ds_read_b128 v[68:71], v82 offset:2144
    s_waitcnt lgkmcnt(6)
    v_mfma_f32_16x16x32_bf16 v[84:87], a[156:159], v[76:79], v[84:87]
    v_mfma_f32_16x16x32_bf16 v[88:91], a[160:163], v[76:79], v[88:91]
    v_mfma_f32_16x16x32_bf16 v[164:167], v[16:19], v[24:27], 0
    v_mfma_f32_16x16x32_bf16 v[168:171], v[20:23], v[24:27], 0
    v_lshlrev_b32 v32, 16, v28
    ds_read_b128 v[72:75], v82 offset:2208
    s_waitcnt lgkmcnt(6)
    v_mfma_f32_16x16x32_bf16 v[84:87], a[160:163], v[48:51], v[84:87]
    v_mfma_f32_16x16x32_bf16 v[88:91], a[164:167], v[48:51], v[88:91]
    v_and_b32 v33, 0xffff0000, v28
    v_lshlrev_b32 v34, 16, v29
    v_and_b32 v35, 0xffff0000, v29
    ds_read_b128 v[76:79], v82 offset:2240
    s_waitcnt lgkmcnt(6)
    v_mfma_f32_16x16x32_bf16 v[84:87], a[164:167], v[52:55], v[84:87]
    v_mfma_f32_16x16x32_bf16 v[88:91], a[168:171], v[52:55], v[88:91]
    v_lshlrev_b32 v36, 16, v30
    v_and_b32 v37, 0xffff0000, v30
    v_lshlrev_b32 v38, 16, v31
    ds_read_b128 v[48:51], v82 offset:2304
    s_waitcnt lgkmcnt(6)
    v_mfma_f32_16x16x32_bf16 v[84:87], a[168:171], v[56:59], v[84:87]
    v_mfma_f32_16x16x32_bf16 v[88:91], a[172:175], v[56:59], v[88:91]
    v_and_b32 v39, 0xffff0000, v31
    v_lshlrev_b32 v40, 16, v16
    v_and_b32 v41, 0xffff0000, v16
    ds_read_b128 v[52:55], v82 offset:2336
    s_waitcnt lgkmcnt(6)
    v_mfma_f32_16x16x32_bf16 v[84:87], a[172:175], v[60:63], v[84:87]
    v_mfma_f32_16x16x32_bf16 v[88:91], a[176:179], v[60:63], v[88:91]
    v_mul_f32 v40, v40, v32
    v_mul_f32 v41, v41, v33
    v_cvt_pk_bf16_f32 v16, v40, v41
    ds_read_b128 v[56:59], v82 offset:2400
    s_waitcnt lgkmcnt(6)
    v_mfma_f32_16x16x32_bf16 v[84:87], a[176:179], v[64:67], v[84:87]
    v_mfma_f32_16x16x32_bf16 v[88:91], a[180:183], v[64:67], v[88:91]
    v_lshlrev_b32 v42, 16, v17
    v_and_b32 v43, 0xffff0000, v17
    v_mul_f32 v42, v42, v34
    ds_read_b128 v[60:63], v82 offset:2432
    s_waitcnt lgkmcnt(6)
    v_mfma_f32_16x16x32_bf16 v[84:87], a[180:183], v[68:71], v[84:87]
    v_mfma_f32_16x16x32_bf16 v[88:91], a[184:187], v[68:71], v[88:91]
    v_mul_f32 v43, v43, v35
    v_cvt_pk_bf16_f32 v17, v42, v43
    v_lshlrev_b32 v40, 16, v18
    ds_read_b128 v[64:67], v82 offset:2496
    s_waitcnt lgkmcnt(6)
    v_mfma_f32_16x16x32_bf16 v[84:87], a[184:187], v[72:75], v[84:87]
    v_mfma_f32_16x16x32_bf16 v[88:91], a[188:191], v[72:75], v[88:91]
    v_and_b32 v41, 0xffff0000, v18
    v_mul_f32 v40, v40, v36
    v_mul_f32 v41, v41, v37
    s_mov_b32 s62, 0
    s_waitcnt vmcnt(0)
    s_branch L_poll_M_chk
L_poll_M:
    buffer_load_dwordx2 v[252:253], v248, s[52:55], 0 offen sc1
    s_waitcnt vmcnt(0)
L_poll_M_chk:
    v_cmp_ne_u64 vcc, s[80:81], v[252:253]
    s_add_u32 s62, s62, 1
    s_cbranch_vccz L_poll_M_ok
    s_cmp_gt_u32 s62, 4194304
    s_cbranch_scc1 L_poll_M_ok
    s_sleep 6
    s_branch L_poll_M
L_poll_M_ok:
    ds_read_b128 v[68:71], v82 offset:2528
    s_waitcnt lgkmcnt(6)
    v_mfma_f32_16x16x32_bf16 v[84:87], a[188:191], v[76:79], v[84:87]
    v_mfma_f32_16x16x32_bf16 v[88:91], a[192:195], v[76:79], v[88:91]
    v_cvt_pk_bf16_f32 v18, v40, v41
    v_lshlrev_b32 v42, 16, v19
    v_and_b32 v43, 0xffff0000, v19
    buffer_load_dwordx4 a[0:3], v9, s[52:55], s79 offen offset:0 sc1
    ds_read_b128 v[72:75], v82 offset:2592
    s_waitcnt lgkmcnt(6)
    v_mfma_f32_16x16x32_bf16 v[84:87], a[192:195], v[48:51], v[84:87]
    v_mfma_f32_16x16x32_bf16 v[88:91], a[196:199], v[48:51], v[88:91]
    v_mul_f32 v42, v42, v38
    v_mul_f32 v43, v43, v39
    v_cvt_pk_bf16_f32 v19, v42, v43
    ds_read_b128 v[76:79], v82 offset:2624
    s_waitcnt lgkmcnt(6)
    v_mfma_f32_16x16x32_bf16 v[84:87], a[196:199], v[52:55], v[84:87]
    v_mfma_f32_16x16x32_bf16 v[88:91], a[200:203], v[52:55], v[88:91]
    buffer_store_dwordx4 v[16:19], v9, s[52:55], s40 offen sc1
    v_lshlrev_b32 v40, 16, v20
    v_and_b32 v41, 0xffff0000, v20
    buffer_load_dwordx4 a[4:7], v9, s[52:55], s79 offen offset:1024 sc1
    ds_read_b128 v[48:51], v82 offset:2688
    s_waitcnt lgkmcnt(6)
    v_mfma_f32_16x16x32_bf16 v[84:87], a[200:203], v[56:59], v[84:87]
    v_mfma_f32_16x16x32_bf16 v[88:91], a[204:207], v[56:59], v[88:91]
    v_mul_f32 v40, v40, v32
    v_mul_f32 v41, v41, v33
    v_cvt_pk_bf16_f32 v20, v40, v41
    ds_read_b128 v[52:55], v82 offset:2720
    s_waitcnt lgkmcnt(6)
    v_mfma_f32_16x16x32_bf16 v[84:87], a[204:207], v[60:63], v[84:87]
    v_mfma_f32_16x16x32_bf16 v[88:91], a[208:211], v[60:63], v[88:91]
    v_lshlrev_b32 v42, 16, v21
    v_and_b32 v43, 0xffff0000, v21
    v_mul_f32 v42, v42, v34
    buffer_load_dwordx4 a[8:11], v9, s[52:55], s79 offen offset:2048 sc1
    ds_read_b128 v[56:59], v82 offset:2784
    s_waitcnt lgkmcnt(6)
    v_mfma_f32_16x16x32_bf16 v[84:87], a[208:211], v[64:67], v[84:87]
    v_mfma_f32_16x16x32_bf16 v[88:91], a[212:215], v[64:67], v[88:91]
    v_mul_f32 v43, v43, v35
    v_cvt_pk_bf16_f32 v21, v42, v43
    v_lshlrev_b32 v40, 16, v22
    ds_read_b128 v[60:63], v82 offset:2816
    s_waitcnt lgkmcnt(6)
    v_mfma_f32_16x16x32_bf16 v[84:87], a[212:215], v[68:71], v[84:87]
    v_mfma_f32_16x16x32_bf16 v[88:91], a[216:219], v[68:71], v[88:91]
    v_and_b32 v41, 0xffff0000, v22
    v_mul_f32 v40, v40, v36
    v_mul_f32 v41, v41, v37
    buffer_load_dwordx4 a[12:15], v9, s[52:55], s79 offen offset:3072 sc1
    s_add_u32 s79, s79, 4096
    s_cmp_eq_u32 s79, s97
    s_cselect_b32 s60, 57344, 0
    s_sub_u32 s79, s79, s60
    ds_read_b128 v[64:67], v82 offset:2880
    s_waitcnt lgkmcnt(6)
    v_mfma_f32_16x16x32_bf16 v[84:87], a[216:219], v[72:75], v[84:87]
    v_mfma_f32_16x16x32_bf16 v[88:91], a[220:223], v[72:75], v[88:91]
    v_cvt_pk_bf16_f32 v22, v40, v41
    v_lshlrev_b32 v42, 16, v23
    v_and_b32 v43, 0xffff0000, v23
    ds_read_b128 v[68:71], v82 offset:2912
    s_waitcnt lgkmcnt(6)
    v_mfma_f32_16x16x32_bf16 v[84:87], a[220:223], v[76:79], v[84:87]
    v_mfma_f32_16x16x32_bf16 v[88:91], a[224:227], v[76:79], v[88:91]
    v_mul_f32 v42, v42, v38
    v_mul_f32 v43, v43, v39
    v_cvt_pk_bf16_f32 v23, v42, v43
    buffer_load_dwordx4 a[16:19], v9, s[52:55], s79 offen offset:0 sc1
    ds_read_b128 v[72:75], v82 offset:2976
    s_waitcnt lgkmcnt(6)
    v_mfma_f32_16x16x32_bf16 v[84:87], a[224:227], v[48:51], v[84:87]
    v_mfma_f32_16x16x32_bf16 v[88:91], a[228:231], v[48:51], v[88:91]
    buffer_store_dwordx4 v[20:23], v9, s[52:55], s41 offen sc1
    s_mov_b32 exec_lo, 0x00030003
    s_mov_b32 exec_hi, 0x00030003
    buffer_store_dwordx4 v[164:167], v13, s[52:55], s42 offen sc1
    buffer_store_dwordx4 v[168:171], v13, s[52:55], s42 offen offset:256 sc1
    s_mov_b64 exec, -1
    s_waitcnt vmcnt(10)
    ds_read_b128 v[76:79], v82 offset:3008
    s_waitcnt lgkmcnt(6)
    v_mfma_f32_16x16x32_bf16 v[84:87], a[228:231], v[52:55], v[84:87]
    v_mfma_f32_16x16x32_bf16 v[88:91], a[232:235], v[52:55], v[88:91]
    s_mov_b32 s62, 0
L_ver_e:
    v_max3_u32 v154, v125, v109, v111
    v_max3_u32 v154, v154, v113, v115
    v_max3_u32 v154, v154, v117, v119
    v_max3_u32 v154, v154, v121, v123
    v_min3_u32 v155, v125, v109, v111
    v_min3_u32 v155, v155, v113, v115
    v_min3_u32 v155, v155, v117, v119
    v_min3_u32 v155, v155, v121, v123
    v_cmp_ne_u32 vcc, s80, v154
    v_cmp_ne_u32 s[60:61], s80, v155
    s_nop 0
    s_or_b64 vcc, vcc, s[60:61]
    s_cbranch_vccz L_ver_e_ok
    s_add_u32 s62, s62, 1
    s_cmp_gt_u32 s62, 4194304
    s_cbranch_scc1 L_ver_e_ok
    buffer_load_dwordx2 v[124:125], v161, s[52:55], 0 offen sc1
    buffer_load_dwordx4 v[108:111], v159, s[52:55], 0 offen offset:0 sc1
    buffer_load_dwordx4 v[112:115], v159, s[52:55], 0 offen offset:256 sc1
    buffer_load_dwordx4 v[116:119], v159, s[52:55], 0 offen offset:2048 sc1
    buffer_load_dwordx4 v[120:123], v159, s[52:55], 0 offen offset:2304 sc1
    s_waitcnt vmcnt(0)
    s_branch L_ver_e
L_ver_e_ok:
    v_add_f32_dpp v124, v124, v124 quad_perm:[1,0,3,2] row_mask:0xf bank_mask:0xf
    s_lshl_b32 s63, s5, 4
    s_add_u32 s63, s63, 8
    buffer_load_dwordx4 a[20:23], v9, s[52:55], s79 offen offset:1024 sc1
    ds_read_b128 v[48:51], v82 offset:3072
    s_waitcnt lgkmcnt(6)
    v_mfma_f32_16x16x32_bf16 v[84:87], a[232:235], v[56:59], v[84:87]
    v_mfma_f32_16x16x32_bf16 v[88:91], a[236:239], v[56:59], v[88:91]
    v_add_f32_dpp v124, v124, v124 quad_perm:[2,3,0,1] row_mask:0xf bank_mask:0xf
    v_lshlrev_b32 v148, 16, v126
    v_cvt_pk_bf16_f32 v124, v124, v124
    ds_read_b128 v[52:55], v82 offset:3104
    s_waitcnt lgkmcnt(6)
    v_mfma_f32_16x16x32_bf16 v[84:87], a[236:239], v[60:63], v[84:87]
    v_mfma_f32_16x16x32_bf16 v[88:91], a[240:243], v[60:63], v[88:91]
    v_and_b32 v124, 0xffff0000, v124
    v_add_f32 v125, 1.0, v124
    v_cvt_pk_bf16_f32 v125, v125, v125
    buffer_load_dwordx4 a[24:27], v9, s[52:55], s79 offen offset:2048 sc1
    ds_read_b128 v[56:59], v82 offset:3168
    s_waitcnt lgkmcnt(6)
    v_mfma_f32_16x16x32_bf16 v[84:87], a[240:243], v[64:67], v[84:87]
    v_mfma_f32_16x16x32_bf16 v[88:91], a[244:247], v[64:67], v[88:91]
    v_and_b32 v125, 0xffff0000, v125
    v_readlane_b32 s63, v124, s63
    v_readlane_b32 s24, v125, 4
    ds_read_b128 v[60:63], v82 offset:3200
    s_waitcnt lgkmcnt(6)
    v_mfma_f32_16x16x32_bf16 v[84:87], a[244:247], v[68:71], v[84:87]
    v_mfma_f32_16x16x32_bf16 v[88:91], a[248:251], v[68:71], v[88:91]
    v_readlane_b32 s28, v124, 0
    v_readlane_b32 s25, v125, 20
    v_readlane_b32 s29, v124, 16
    buffer_load_dwordx4 a[28:31], v9, s[52:55], s79 offen offset:3072 sc1
    s_add_u32 s79, s79, 4096
    s_cmp_eq_u32 s79, s97
    s_cselect_b32 s60, 57344, 0
    s_sub_u32 s79, s79, s60
    ds_read_b128 v[64:67], v82 offset:3264
    s_waitcnt lgkmcnt(6)
    v_mfma_f32_16x16x32_bf16 v[84:87], a[248:251], v[72:75], v[84:87]
    v_mfma_f32_16x16x32_bf16 v[88:91], a[252:255], v[72:75], v[88:91]
    v_readlane_b32 s26, v125, 36
    v_readlane_b32 s30, v124, 32
    v_readlane_b32 s27, v125, 52
    ds_read_b128 v[68:71], v82 offset:3296
    s_waitcnt lgkmcnt(6)
    v_mfma_f32_16x16x32_bf16 v[84:87], a[252:255], v[76:79], v[84:87]
    v_mfma_f32_16x16x32_bf16 v[88:91], v[176:179], v[76:79], v[88:91]
    v_readlane_b32 s31, v124, 48
    v_mov_b32 v149, s63
    v_mov_b32 v128, s24
    buffer_load_dwordx4 a[32:35], v9, s[52:55], s79 offen offset:0 sc1
    ds_read_b128 v[72:75], v82 offset:3360
    s_waitcnt lgkmcnt(6)
    v_mfma_f32_16x16x32_bf16 v[84:87], v[176:179], v[48:51], v[84:87]
    v_mfma_f32_16x16x32_bf16 v[88:91], v[180:183], v[48:51], v[88:91]
    v_mov_b32 v129, s25
    v_mov_b32 v130, s26
    v_mov_b32 v131, s27
    ds_read_b128 v[76:79], v82 offset:3392
    s_waitcnt lgkmcnt(6)
    v_mfma_f32_16x16x32_bf16 v[84:87], v[180:183], v[52:55], v[84:87]
    v_mfma_f32_16x16x32_bf16 v[88:91], v[184:187], v[52:55], v[88:91]
    v_mov_b32 v132, s28
    v_mov_b32 v133, s29
    v_mov_b32 v134, s30
    buffer_load_dwordx4 a[36:39], v9, s[52:55], s79 offen offset:1024 sc1
    ds_read_b128 v[48:51], v82 offset:3456
    s_waitcnt lgkmcnt(6)
    v_mfma_f32_16x16x32_bf16 v[84:87], v[184:187], v[56:59], v[84:87]
    v_mfma_f32_16x16x32_bf16 v[88:91], v[188:191], v[56:59], v[88:91]
    v_mov_b32 v135, s31
    ds_read_b64 v[140:141], v156 offset:32
    ds_read_b64 v[142:143], v156 offset:0
    ds_read_b128 v[52:55], v82 offset:3488
    s_waitcnt lgkmcnt(6)
    v_mfma_f32_16x16x32_bf16 v[84:87], v[188:191], v[60:63], v[84:87]
    v_mfma_f32_16x16x32_bf16 v[88:91], v[192:195], v[60:63], v[88:91]
    ds_read_b64 v[144:145], v157 offset:32
    ds_read_b64 v[146:147], v157 offset:0
    buffer_load_dwordx4 a[40:43], v9, s[52:55], s79 offen offset:2048 sc1
    ds_read_b128 v[56:59], v82 offset:3552
    s_waitcnt lgkmcnt(6)
    v_mfma_f32_16x16x32_bf16 v[84:87], v[192:195], v[64:67], v[84:87]
    v_mfma_f32_16x16x32_bf16 v[88:91], v[196:199], v[64:67], v[88:91]
    ds_read_b128 v[60:63], v82 offset:3584
    s_waitcnt lgkmcnt(6)
    v_mfma_f32_16x16x32_bf16 v[84:87], v[196:199], v[68:71], v[84:87]
    v_mfma_f32_16x16x32_bf16 v[88:91], v[200:203], v[68:71], v[88:91]
    buffer_load_dwordx4 a[44:47], v9, s[52:55], s79 offen offset:3072 sc1
    s_add_u32 s79, s79, 4096
    s_cmp_eq_u32 s79, s97
    s_cselect_b32 s60, 57344, 0
    s_sub_u32 s79, s79, s60
    ds_read_b128 v[64:67], v82 offset:3648
    s_waitcnt lgkmcnt(6)
    v_mfma_f32_16x16x32_bf16 v[84:87], v[200:203], v[72:75], v[84:87]
    v_mfma_f32_16x16x32_bf16 v[88:91], v[204:207], v[72:75], v[88:91]
    ds_read_b128 v[68:71], v82 offset:3680
    s_waitcnt lgkmcnt(6)
    v_mfma_f32_16x16x32_bf16 v[84:87], v[204:207], v[76:79], v[84:87]
    v_mfma_f32_16x16x32_bf16 v[88:91], v[208:211], v[76:79], v[88:91]
    buffer_load_dwordx4 a[48:51], v9, s[52:55], s79 offen offset:0 sc1
    ds_read_b128 v[72:75], v82 offset:3744
    s_waitcnt lgkmcnt(6)
    v_mfma_f32_16x16x32_bf16 v[84:87], v[208:211], v[48:51], v[84:87]
    v_mfma_f32_16x16x32_bf16 v[88:91], v[212:215], v[48:51], v[88:91]
    ds_read_b128 v[76:79], v82 offset:3776
    s_waitcnt lgkmcnt(6)
    v_mfma_f32_16x16x32_bf16 v[84:87], v[212:215], v[52:55], v[84:87]
    v_mfma_f32_16x16x32_bf16 v[88:91], v[216:219], v[52:55], v[88:91]
    buffer_load_dwordx4 a[52:55], v9, s[52:55], s79 offen offset:1024 sc1
    s_waitcnt lgkmcnt(5)
    v_mfma_f32_16x16x32_bf16 v[84:87], v[216:219], v[56:59], v[84:87]
    v_mfma_f32_16x16x32_bf16 v[88:91], v[220:223], v[56:59], v[88:91]
    s_waitcnt lgkmcnt(4)
    v_mfma_f32_16x16x32_bf16 v[84:87], v[220:223], v[60:63], v[84:87]
    v_mfma_f32_16x16x32_bf16 v[88:91], v[224:227], v[60:63], v[88:91]
    buffer_load_dwordx4 a[56:59], v9, s[52:55], s79 offen offset:2048 sc1
    s_waitcnt lgkmcnt(3)
    v_mfma_f32_16x16x32_bf16 v[84:87], v[224:227], v[64:67], v[84:87]
    v_mfma_f32_16x16x32_bf16 v[88:91], v[228:231], v[64:67], v[88:91]
    s_waitcnt lgkmcnt(2)
    v_mfma_f32_16x16x32_bf16 v[84:87], v[228:231], v[68:71], v[84:87]
    v_mfma_f32_16x16x32_bf16 v[88:91], v[232:235], v[68:71], v[88:91]
    s_waitcnt lgkmcnt(1)
    v_mfma_f32_16x16x32_bf16 v[84:87], v[232:235], v[72:75], v[84:87]
    v_mfma_f32_16x16x32_bf16 v[88:91], v[236:239], v[72:75], v[88:91]
    s_waitcnt lgkmcnt(0)
    v_mfma_f32_16x16x32_bf16 v[84:87], v[236:239], v[76:79], v[84:87]
    v_mfma_f32_16x16x32_bf16 v[88:91], v[240:243], v[76:79], v[88:91]
    s_waitcnt lgkmcnt(0)
    v_and_b32 v160, 0xffff0000, v141
    v_lshlrev_b32 v161, 16, v141
    v_and_b32 v162, 0xffff0000, v140
    v_lshlrev_b32 v163, 16, v140
    v_pk_fma_f32 v[160:161], v[160:161], v[148:149], v[92:93] op_sel_hi:[1,0,1]
    v_pk_fma_f32 v[162:163], v[162:163], v[148:149], v[94:95] op_sel_hi:[1,0,1]
    v_pk_mul_f32 v[160:161], v[160:161], v[148:149] op_sel:[0,1] op_sel_hi:[1,1]
    v_pk_mul_f32 v[162:163], v[162:163], v[148:149] op_sel:[0,1] op_sel_hi:[1,1]
    v_cvt_pk_bf16_f32 v168, v160, v161
    v_cvt_pk_bf16_f32 v169, v162, v163
    ds_write_b64 v150, v[168:169] offset:0
    v_and_b32 v164, 0xffff0000, v143
    v_lshlrev_b32 v165, 16, v143
    v_and_b32 v166, 0xffff0000, v142
    v_lshlrev_b32 v167, 16, v142
    v_pk_fma_f32 v[164:165], v[164:165], v[148:149], v[96:97] op_sel_hi:[1,0,1]
    v_pk_fma_f32 v[166:167], v[166:167], v[148:149], v[98:99] op_sel_hi:[1,0,1]
    v_pk_mul_f32 v[164:165], v[164:165], v[148:149] op_sel:[0,1] op_sel_hi:[1,1]
    v_pk_mul_f32 v[166:167], v[166:167], v[148:149] op_sel:[0,1] op_sel_hi:[1,1]
    v_cvt_pk_bf16_f32 v170, v164, v165
    v_cvt_pk_bf16_f32 v171, v166, v167
    ds_write_b64 v150, v[170:171] offset:576
    v_and_b32 v160, 0xffff0000, v145
    v_lshlrev_b32 v161, 16, v145
    v_and_b32 v162, 0xffff0000, v144
    v_lshlrev_b32 v163, 16, v144
    v_pk_fma_f32 v[160:161], v[160:161], v[148:149], v[84:85] op_sel_hi:[1,0,1]
    v_pk_fma_f32 v[162:163], v[162:163], v[148:149], v[86:87] op_sel_hi:[1,0,1]
    v_pk_mul_f32 v[160:161], v[160:161], v[148:149] op_sel:[0,1] op_sel_hi:[1,1]
    v_pk_mul_f32 v[162:163], v[162:163], v[148:149] op_sel:[0,1] op_sel_hi:[1,1]
    v_cvt_pk_bf16_f32 v168, v160, v161
    v_cvt_pk_bf16_f32 v169, v162, v163
    ds_write_b64 v150, v[168:169] offset:1152
    v_and_b32 v164, 0xffff0000, v147
    v_lshlrev_b32 v165, 16, v147
    v_and_b32 v166, 0xffff0000, v146
    v_lshlrev_b32 v167, 16, v146
    v_pk_fma_f32 v[164:165], v[164:165], v[148:149], v[88:89] op_sel_hi:[1,0,1]
    v_pk_fma_f32 v[166:167], v[166:167], v[148:149], v[90:91] op_sel_hi:[1,0,1]
    v_pk_mul_f32 v[164:165], v[164:165], v[148:149] op_sel:[0,1] op_sel_hi:[1,1]
    v_pk_mul_f32 v[166:167], v[166:167], v[148:149] op_sel:[0,1] op_sel_hi:[1,1]
    v_cvt_pk_bf16_f32 v170, v164, v165
    v_cvt_pk_bf16_f32 v171, v166, v167
    ds_write_b64 v150, v[170:171] offset:1728
    s_waitcnt lgkmcnt(0)
    s_barrier
    ds_read_b64 v[100:101], v152
    ds_read_b64 v[102:103], v152 offset:256
    ds_read_b64 v[104:105], v152 offset:2048
    ds_read_b64 v[106:107], v152 offset:2304
    ds_read_b64_tr_b16 v[160:161], v151
    ds_read_b64_tr_b16 v[162:163], v151 offset:576
    ds_read_b64_tr_b16 v[164:165], v151 offset:32
    ds_read_b64_tr_b16 v[166:167], v151 offset:608
    s_waitcnt lgkmcnt(7)
    v_lshlrev_b32 v64, 16, v100
    v_and_b32 v65, 0xffff0000, v100
    v_lshlrev_b32 v66, 16, v101
    v_and_b32 v67, 0xffff0000, v101
    v_pk_fma_f32 v[68:69], v[64:65], v[108:109], v[110:111] op_sel_hi:[1,0,0]
    v_pk_fma_f32 v[70:71], v[66:67], v[108:109], v[110:111] op_sel_hi:[1,0,0]
    v_pk_fma_f32 v[68:69], v[68:69], v[128:129], v[132:133]
    v_pk_fma_f32 v[70:71], v[70:71], v[130:131], v[134:135]
    s_waitcnt lgkmcnt(6)
    v_lshlrev_b32 v72, 16, v102
    v_and_b32 v73, 0xffff0000, v102
    v_lshlrev_b32 v74, 16, v103
    v_and_b32 v75, 0xffff0000, v103
    v_pk_fma_f32 v[76:77], v[72:73], v[112:113], v[114:115] op_sel_hi:[1,0,0]
    v_pk_fma_f32 v[78:79], v[74:75], v[112:113], v[114:115] op_sel_hi:[1,0,0]
    v_pk_fma_f32 v[76:77], v[76:77], v[128:129], v[132:133]
    v_pk_fma_f32 v[78:79], v[78:79], v[130:131], v[134:135]
    s_waitcnt lgkmcnt(3)
    v_lshlrev_b32 v140, 16, v160
    v_and_b32 v141, 0xffff0000, v160
    v_lshlrev_b32 v142, 16, v161
    v_and_b32 v143, 0xffff0000, v161
    v_pk_fma_f32 v[64:65], v[68:69], v[140:141], v[64:65]
    v_pk_fma_f32 v[66:67], v[70:71], v[142:143], v[66:67]
    v_cvt_pk_bf16_f32 v160, v64, v65
    v_cvt_pk_bf16_f32 v161, v66, v67
    s_waitcnt lgkmcnt(2)
    v_lshlrev_b32 v144, 16, v162
    v_and_b32 v145, 0xffff0000, v162
    v_lshlrev_b32 v146, 16, v163
    v_and_b32 v147, 0xffff0000, v163
    v_pk_fma_f32 v[72:73], v[76:77], v[144:145], v[72:73]
    v_pk_fma_f32 v[74:75], v[78:79], v[146:147], v[74:75]
    v_cvt_pk_bf16_f32 v162, v72, v73
    v_cvt_pk_bf16_f32 v163, v74, v75
    buffer_store_dwordx4 v[160:163], v153, s[52:55], s66 offen sc1
    s_waitcnt lgkmcnt(5)
    v_lshlrev_b32 v80, 16, v104
    v_and_b32 v81, 0xffff0000, v104
    v_lshlrev_b32 v82, 16, v105
    v_and_b32 v83, 0xffff0000, v105
    v_pk_fma_f32 v[84:85], v[80:81], v[116:117], v[118:119] op_sel_hi:[1,0,0]
    v_pk_fma_f32 v[86:87], v[82:83], v[116:117], v[118:119] op_sel_hi:[1,0,0]
    v_pk_fma_f32 v[84:85], v[84:85], v[128:129], v[132:133]
    v_pk_fma_f32 v[86:87], v[86:87], v[130:131], v[134:135]
    s_waitcnt lgkmcnt(4)
    v_lshlrev_b32 v88, 16, v106
    v_and_b32 v89, 0xffff0000, v106
    v_lshlrev_b32 v90, 16, v107
    v_and_b32 v91, 0xffff0000, v107
    v_pk_fma_f32 v[92:93], v[88:89], v[120:121], v[122:123] op_sel_hi:[1,0,0]
    v_pk_fma_f32 v[94:95], v[90:91], v[120:121], v[122:123] op_sel_hi:[1,0,0]
    v_pk_fma_f32 v[92:93], v[92:93], v[128:129], v[132:133]
    v_pk_fma_f32 v[94:95], v[94:95], v[130:131], v[134:135]
    s_waitcnt lgkmcnt(1)
    v_lshlrev_b32 v140, 16, v164
    v_and_b32 v141, 0xffff0000, v164
    v_lshlrev_b32 v142, 16, v165
    v_and_b32 v143, 0xffff0000, v165
    v_pk_fma_f32 v[80:81], v[84:85], v[140:141], v[80:81]
    v_pk_fma_f32 v[82:83], v[86:87], v[142:143], v[82:83]
    v_cvt_pk_bf16_f32 v164, v80, v81
    v_cvt_pk_bf16_f32 v165, v82, v83
    s_waitcnt lgkmcnt(0)
    v_lshlrev_b32 v144, 16, v166
    v_and_b32 v145, 0xffff0000, v166
    v_lshlrev_b32 v146, 16, v167
    v_and_b32 v147, 0xffff0000, v167
    v_pk_fma_f32 v[88:89], v[92:93], v[144:145], v[88:89]
    v_pk_fma_f32 v[90:91], v[94:95], v[146:147], v[90:91]
    v_cvt_pk_bf16_f32 v166, v88, v89
    v_cvt_pk_bf16_f32 v167, v90, v91
    buffer_store_dwordx4 v[164:167], v153, s[52:55], s67 offen sc1
    s_waitcnt vmcnt(0)
    s_barrier
    s_cmp_lg_u32 s5, 0
    s_cbranch_scc1 L_sig2_skip
    s_lshl_b32 s60, s2, 6
    s_add_u32 s60, s60, 19922944
    v_lshl_add_u32 v6, v1, 14, s60
    v_mov_b32 v4, s80
    v_mov_b32 v5, s81
    s_mov_b64 exec, 255
    buffer_store_dwordx2 v[4:5], v6, s[52:55], 0 offen sc1
    s_mov_b64 exec, -1
L_sig2_skip:
    s_lshl_b32 s64, s74, 2
    s_add_u32 s64, s64, s5
    s_lshl_b32 s64, s64, 15
    s_add_u32 s64, s64, 4194304
    s_lshl_b32 s65, s75, 4
    s_add_u32 s65, s65, s5
    s_mul_i32 s65, s65, 7168
    s_add_u32 s65, s65, 22020096
    s_mul_i32 s66, s5, 7168
    s_add_u32 s66, s66, 32768
    s_lshl_b32 s67, s75, 2
    s_add_u32 s67, s67, s5
    s_lshl_b32 s67, s67, 12
    s_add_u32 s67, s67, 24117248
    s_mov_b32 s44, s64
    s_mul_i32 s45, s75, 114688
    s_add_u32 s45, s45, 22020096
    v_lshlrev_b32 v8, 4, v1
    v_add_u32 v10, 32768, v8
    v_add_u32 v11, 57344, v10
    v_lshlrev_b32 v248, 2, v0
    v_add_u32 v249, 147456, v248
    v_mov_b32 v12, 0x3f803f80
    v_mov_b32 v13, 0x3f803f80
    v_mov_b32 v14, 0x3f803f80
    v_mov_b32 v15, 0x3f803f80
    buffer_load_dwordx4 a[60:63], v9, s[52:55], s79 offen offset:3072 sc1
    s_add_u32 s79, s79, 4096
    s_cmp_eq_u32 s79, s97
    s_cselect_b32 s60, 57344, 0
    s_sub_u32 s79, s79, s60
    buffer_load_dwordx4 a[64:67], v9, s[52:55], s79 offen offset:0 sc1
    buffer_load_dwordx4 a[68:71], v9, s[52:55], s79 offen offset:1024 sc1
    buffer_load_dwordx4 a[72:75], v9, s[52:55], s79 offen offset:2048 sc1
    buffer_load_dwordx4 a[76:79], v9, s[52:55], s79 offen offset:3072 sc1
    s_add_u32 s79, s79, 4096
    s_cmp_eq_u32 s79, s97
    s_cselect_b32 s60, 57344, 0
    s_sub_u32 s79, s79, s60
    buffer_load_dwordx4 a[80:83], v9, s[52:55], s79 offen offset:0 sc1
    buffer_load_dwordx4 a[84:87], v9, s[52:55], s79 offen offset:1024 sc1
    buffer_load_dwordx4 a[88:91], v9, s[52:55], s79 offen offset:2048 sc1
    buffer_load_dwordx4 a[92:95], v9, s[52:55], s79 offen offset:3072 sc1
    s_add_u32 s79, s79, 4096
    s_cmp_eq_u32 s79, s97
    s_cselect_b32 s60, 57344, 0
    s_sub_u32 s79, s79, s60
    buffer_load_dwordx4 a[96:99], v9, s[52:55], s79 offen offset:0 sc1
    buffer_load_dwordx4 a[100:103], v9, s[52:55], s79 offen offset:1024 sc1
    buffer_load_dwordx4 a[104:107], v9, s[52:55], s79 offen offset:2048 sc1
    buffer_load_dwordx4 a[108:111], v9, s[52:55], s79 offen offset:3072 sc1
    s_add_u32 s79, s79, 4096
    s_cmp_eq_u32 s79, s97
    s_cselect_b32 s60, 57344, 0
    s_sub_u32 s79, s79, s60
    buffer_load_dwordx4 a[112:115], v9, s[52:55], s79 offen offset:0 sc1
    buffer_load_dwordx4 a[116:119], v9, s[52:55], s79 offen offset:1024 sc1
    buffer_load_dwordx4 a[120:123], v9, s[52:55], s79 offen offset:2048 sc1
    buffer_load_dwordx4 a[124:127], v9, s[52:55], s79 offen offset:3072 sc1
    s_add_u32 s79, s79, 4096
    s_cmp_eq_u32 s79, s97
    s_cselect_b32 s60, 57344, 0
    s_sub_u32 s79, s79, s60
    buffer_load_dwordx4 a[128:131], v9, s[52:55], s79 offen offset:0 sc1
    buffer_load_dwordx4 a[132:135], v9, s[52:55], s79 offen offset:1024 sc1
    buffer_load_dwordx4 a[136:139], v9, s[52:55], s79 offen offset:2048 sc1
    buffer_load_dwordx4 a[140:143], v9, s[52:55], s79 offen offset:3072 sc1
    s_add_u32 s79, s79, 4096
    s_cmp_eq_u32 s79, s97
    s_cselect_b32 s60, 57344, 0
    s_sub_u32 s79, s79, s60
    buffer_load_dwordx4 a[144:147], v9, s[52:55], s79 offen offset:0 sc1
    buffer_load_dwordx4 a[148:151], v9, s[52:55], s79 offen offset:1024 sc1
    buffer_load_dwordx4 a[152:155], v9, s[52:55], s79 offen offset:2048 sc1
    buffer_load_dwordx4 a[156:159], v9, s[52:55], s79 offen offset:3072 sc1
    s_add_u32 s79, s79, 4096
    s_cmp_eq_u32 s79, s97
    s_cselect_b32 s60, 57344, 0
    s_sub_u32 s79, s79, s60
    buffer_load_dwordx4 a[160:163], v9, s[52:55], s79 offen offset:0 sc1
    s_lshl_b32 s60, s3, 14
    s_add_u32 s60, s60, 19922944
    v_lshl_add_u32 v4, v0, 6, s60
    s_mov_b32 s62, 0
L_poll_2:
    buffer_load_dwordx2 v[6:7], v4, s[52:55], 0 offen sc1
    s_waitcnt vmcnt(0)
L_poll_2_chk:
    v_cmp_ne_u64 vcc, s[80:81], v[6:7]
    s_add_u32 s62, s62, 1
    s_cbranch_vccz L_poll_2_ok
    s_cmp_gt_u32 s62, 4194304
    s_cbranch_scc1 L_poll_2_ok
    s_sleep 6
    s_branch L_poll_2
L_poll_2_ok:
    s_barrier
    s_add_u32 m0, s66, 0
    s_add_u32 s60, s65, 0
    buffer_load_dwordx4 v8, s[52:55], s60 offen offset:0 sc1 lds
    buffer_load_dwordx4 v8, s[52:55], s60 offen offset:1024 sc1 lds
    buffer_load_dwordx4 v8, s[52:55], s60 offen offset:2048 sc1 lds
    buffer_load_dwordx4 v8, s[52:55], s60 offen offset:3072 sc1 lds
    buffer_load_dwordx4 v[64:67], v8, s[52:55], s64 offen offset:0 sc1
    buffer_load_dwordx4 v[68:71], v8, s[52:55], s64 offen offset:1024 sc1
    buffer_load_dwordx4 v[72:75], v8, s[52:55], s64 offen offset:2048 sc1
    buffer_load_dwordx4 v[76:79], v8, s[52:55], s64 offen offset:3072 sc1
    s_add_u32 s64, s64, 4096
    buffer_load_dwordx4 v[80:83], v8, s[52:55], s64 offen offset:0 sc1
    buffer_load_dwordx4 v[84:87], v8, s[52:55], s64 offen offset:1024 sc1
    buffer_load_dwordx4 v[88:91], v8, s[52:55], s64 offen offset:2048 sc1
    buffer_load_dwordx4 v[92:95], v8, s[52:55], s64 offen offset:3072 sc1
    s_add_u32 s64, s64, 4096
    s_add_u32 m0, s66, 28672
    s_add_u32 s60, s65, 28672
    buffer_load_dwordx4 v8, s[52:55], s60 offen offset:0 sc1 lds
    buffer_load_dwordx4 v8, s[52:55], s60 offen offset:1024 sc1 lds
    buffer_load_dwordx4 v8, s[52:55], s60 offen offset:2048 sc1 lds
    buffer_load_dwordx4 v8, s[52:55], s60 offen offset:3072 sc1 lds
    buffer_load_dwordx4 v[96:99], v8, s[52:55], s64 offen offset:0 sc1
    buffer_load_dwordx4 v[100:103], v8, s[52:55], s64 offen offset:1024 sc1
    buffer_load_dwordx4 v[104:107], v8, s[52:55], s64 offen offset:2048 sc1
    buffer_load_dwordx4 v[108:111], v8, s[52:55], s64 offen offset:3072 sc1
    s_add_u32 s64, s64, 4096
    s_waitcnt vmcnt(16)
    s_barrier
    ds_read_b128 v[16:19], v10 offset:0
    ds_read_b128 v[20:23], v10 offset:1024
    ds_read_b128 v[24:27], v10 offset:2048
    ds_read_b128 v[28:31], v10 offset:3072
    ds_read_b128 v[32:35], v10 offset:7168
    ds_read_b128 v[36:39], v10 offset:8192
    ds_read_b128 v[40:43], v10 offset:9216
    s_waitcnt vmcnt(14)
    v_swap_b32 v66, v68
    v_swap_b32 v67, v69
    s_waitcnt lgkmcnt(6)
    s_nop 0
    v_mfma_f32_16x16x32_bf16 v[192:195], v[16:19], v[64:67], 0
    buffer_load_dwordx4 v[112:115], v8, s[52:55], s64 offen offset:0 sc1
    v_mfma_f32_16x16x32_bf16 v[196:199], v[16:19], v[68:71], 0
    ds_read_b128 v[44:47], v10 offset:10240
    s_waitcnt lgkmcnt(6)
    v_mfma_f32_16x16x32_bf16 v[200:203], v[20:23], v[64:67], 0
    v_mfma_f32_16x16x32_bf16 v[204:207], v[20:23], v[68:71], 0
    ds_read_b128 v[16:19], v10 offset:14336
    v_mfma_f32_16x16x32_bf16 v[48:51], v[12:15], v[64:67], 0
    buffer_load_dwordx4 v[116:119], v8, s[52:55], s64 offen offset:1024 sc1
    v_mfma_f32_16x16x32_bf16 v[52:55], v[64:67], v[64:67], 0
    s_waitcnt lgkmcnt(6)
    v_mfma_f32_16x16x32_bf16 v[208:211], v[24:27], v[64:67], 0
    v_mfma_f32_16x16x32_bf16 v[212:215], v[24:27], v[68:71], 0
    ds_read_b128 v[20:23], v10 offset:15360
    v_mfma_f32_16x16x32_bf16 v[56:59], v[12:15], v[68:71], 0
    buffer_load_dwordx4 v[120:123], v8, s[52:55], s64 offen offset:2048 sc1
    s_waitcnt vmcnt(15)
    v_swap_b32 v74, v76
    v_swap_b32 v75, v77
    v_mfma_f32_16x16x32_bf16 v[60:63], v[68:71], v[68:71], 0
    s_waitcnt lgkmcnt(6)
    v_mfma_f32_16x16x32_bf16 v[216:219], v[28:31], v[64:67], 0
    v_mfma_f32_16x16x32_bf16 v[220:223], v[28:31], v[68:71], 0
    ds_read_b128 v[24:27], v10 offset:16384
    s_waitcnt lgkmcnt(6)
    v_mfma_f32_16x16x32_bf16 v[192:195], v[32:35], v[72:75], v[192:195]
    buffer_load_dwordx4 v[124:127], v8, s[52:55], s64 offen offset:3072 sc1
    s_add_u32 s64, s64, 4096
    v_mfma_f32_16x16x32_bf16 v[196:199], v[32:35], v[76:79], v[196:199]
    ds_read_b128 v[28:31], v10 offset:17408
    s_waitcnt lgkmcnt(6)
    v_mfma_f32_16x16x32_bf16 v[200:203], v[36:39], v[72:75], v[200:203]
    v_mfma_f32_16x16x32_bf16 v[204:207], v[36:39], v[76:79], v[204:207]
    ds_read_b128 v[32:35], v10 offset:21504
    v_mfma_f32_16x16x32_bf16 v[48:51], v[12:15], v[72:75], v[48:51]
    s_lshl_b32 s60, s5, 12
    s_add_u32 m0, s60, 147456
    s_nop 0
    buffer_load_dwordx4 v8, s[52:55], s67 offen offset:0 sc1 lds
    v_mfma_f32_16x16x32_bf16 v[52:55], v[72:75], v[72:75], v[52:55]
    s_waitcnt lgkmcnt(6)
    v_mfma_f32_16x16x32_bf16 v[208:211], v[40:43], v[72:75], v[208:211]
    v_mfma_f32_16x16x32_bf16 v[212:215], v[40:43], v[76:79], v[212:215]
    ds_read_b128 v[36:39], v10 offset:22528
    v_mfma_f32_16x16x32_bf16 v[56:59], v[12:15], v[76:79], v[56:59]
    buffer_load_dwordx4 v8, s[52:55], s67 offen offset:1024 sc1 lds
    s_waitcnt vmcnt(16)
    v_swap_b32 v82, v84
    v_swap_b32 v83, v85
    v_mfma_f32_16x16x32_bf16 v[60:63], v[76:79], v[76:79], v[60:63]
    s_waitcnt lgkmcnt(6)
    v_mfma_f32_16x16x32_bf16 v[216:219], v[44:47], v[72:75], v[216:219]
    v_mfma_f32_16x16x32_bf16 v[220:223], v[44:47], v[76:79], v[220:223]
    ds_read_b128 v[40:43], v10 offset:23552
    s_waitcnt lgkmcnt(6)
    v_mfma_f32_16x16x32_bf16 v[192:195], v[16:19], v[80:83], v[192:195]
    buffer_load_dwordx4 v8, s[52:55], s67 offen offset:2048 sc1 lds
    v_mfma_f32_16x16x32_bf16 v[196:199], v[16:19], v[84:87], v[196:199]
    ds_read_b128 v[44:47], v10 offset:24576
    s_waitcnt lgkmcnt(6)
    v_mfma_f32_16x16x32_bf16 v[200:203], v[20:23], v[80:83], v[200:203]
    v_mfma_f32_16x16x32_bf16 v[204:207], v[20:23], v[84:87], v[204:207]
    s_waitcnt vmcnt(11)
    s_barrier
    ds_read_b128 v[16:19], v10 offset:28672
    v_mfma_f32_16x16x32_bf16 v[48:51], v[12:15], v[80:83], v[48:51]
    buffer_load_dwordx4 v8, s[52:55], s67 offen offset:3072 sc1 lds
    v_mfma_f32_16x16x32_bf16 v[52:55], v[80:83], v[80:83], v[52:55]
    s_waitcnt lgkmcnt(6)
    v_mfma_f32_16x16x32_bf16 v[208:211], v[24:27], v[80:83], v[208:211]
    v_mfma_f32_16x16x32_bf16 v[212:215], v[24:27], v[84:87], v[212:215]
    ds_read_b128 v[20:23], v10 offset:29696
    v_mfma_f32_16x16x32_bf16 v[56:59], v[12:15], v[84:87], v[56:59]
    s_add_u32 m0, s66, 57344
    s_add_u32 s60, s65, 57344
    buffer_load_dwordx4 v8, s[52:55], s60 offen offset:0 sc1 lds
    s_waitcnt vmcnt(17)
    v_swap_b32 v90, v92
    v_swap_b32 v91, v93
    v_mfma_f32_16x16x32_bf16 v[60:63], v[84:87], v[84:87], v[60:63]
    s_waitcnt lgkmcnt(6)
    v_mfma_f32_16x16x32_bf16 v[216:219], v[28:31], v[80:83], v[216:219]
    v_mfma_f32_16x16x32_bf16 v[220:223], v[28:31], v[84:87], v[220:223]
    ds_read_b128 v[24:27], v10 offset:30720
    s_waitcnt lgkmcnt(6)
    v_mfma_f32_16x16x32_bf16 v[192:195], v[32:35], v[88:91], v[192:195]
    buffer_load_dwordx4 v8, s[52:55], s60 offen offset:1024 sc1 lds
    v_mfma_f32_16x16x32_bf16 v[196:199], v[32:35], v[92:95], v[196:199]
    ds_read_b128 v[28:31], v10 offset:31744
    s_waitcnt lgkmcnt(6)
    v_mfma_f32_16x16x32_bf16 v[200:203], v[36:39], v[88:91], v[200:203]
    v_mfma_f32_16x16x32_bf16 v[204:207], v[36:39], v[92:95], v[204:207]
    ds_read_b128 v[32:35], v10 offset:35840
    v_mfma_f32_16x16x32_bf16 v[48:51], v[12:15], v[88:91], v[48:51]
    buffer_load_dwordx4 v8, s[52:55], s60 offen offset:2048 sc1 lds
    v_lshlrev_b32 v4, 4, v3
    v_lshrrev_b32 v5, 2, v2
    v_mfma_f32_16x16x32_bf16 v[52:55], v[88:91], v[88:91], v[52:55]
    v_lshl_add_u32 v5, v5, 4, v2
    v_lshlrev_b32 v5, 2, v5
    s_waitcnt lgkmcnt(6)
    v_mfma_f32_16x16x32_bf16 v[208:211], v[40:43], v[88:91], v[208:211]
    v_mfma_f32_16x16x32_bf16 v[212:215], v[40:43], v[92:95], v[212:215]
    ds_read_b128 v[36:39], v10 offset:36864
    v_mfma_f32_16x16x32_bf16 v[56:59], v[12:15], v[92:95], v[56:59]
    buffer_load_dwordx4 v8, s[52:55], s60 offen offset:3072 sc1 lds
    s_waitcnt vmcnt(14)
    v_swap_b32 v98, v100
    v_swap_b32 v99, v101
    v_mfma_f32_16x16x32_bf16 v[60:63], v[92:95], v[92:95], v[60:63]
    v_and_b32 v6, 3, v1
    v_cmp_eq_u32 s[20:21], 1, v6
    s_waitcnt lgkmcnt(6)
    v_mfma_f32_16x16x32_bf16 v[216:219], v[44:47], v[88:91], v[216:219]
    v_mfma_f32_16x16x32_bf16 v[220:223], v[44:47], v[92:95], v[220:223]
    ds_read_b128 v[40:43], v10 offset:37888
    s_waitcnt lgkmcnt(6)
    v_mfma_f32_16x16x32_bf16 v[192:195], v[16:19], v[96:99], v[192:195]
    buffer_load_dwordx4 v[128:131], v8, s[52:55], s64 offen offset:0 sc1
    v_mfma_f32_16x16x32_bf16 v[196:199], v[16:19], v[100:103], v[196:199]
    ds_read_b128 v[44:47], v10 offset:38912
    s_waitcnt lgkmcnt(6)
    v_mfma_f32_16x16x32_bf16 v[200:203], v[20:23], v[96:99], v[200:203]
    v_mfma_f32_16x16x32_bf16 v[204:207], v[20:23], v[100:103], v[204:207]
    ds_read_b128 v[16:19], v10 offset:43008
    v_mfma_f32_16x16x32_bf16 v[48:51], v[12:15], v[96:99], v[48:51]
    buffer_load_dwordx4 v[132:135], v8, s[52:55], s64 offen offset:1024 sc1
    v_cmp_eq_u32 s[22:23], 2, v6
    v_cmp_eq_u32 s[40:41], 3, v6
    v_mfma_f32_16x16x32_bf16 v[52:55], v[96:99], v[96:99], v[52:55]
    s_lshl_b32 s44, s74, 1
    s_lshr_b32 s61, s5, 1
    s_waitcnt lgkmcnt(6)
    v_mfma_f32_16x16x32_bf16 v[208:211], v[24:27], v[96:99], v[208:211]
    v_mfma_f32_16x16x32_bf16 v[212:215], v[24:27], v[100:103], v[212:215]
    ds_read_b128 v[20:23], v10 offset:44032
    v_mfma_f32_16x16x32_bf16 v[56:59], v[12:15], v[100:103], v[56:59]
    buffer_load_dwordx4 v[136:139], v8, s[52:55], s64 offen offset:2048 sc1
    s_waitcnt vmcnt(15)
    v_swap_b32 v106, v108
    v_swap_b32 v107, v109
    v_mfma_f32_16x16x32_bf16 v[60:63], v[100:103], v[100:103], v[60:63]
    s_add_u32 s44, s44, s61
    s_lshl_b32 s46, s44, 4
    s_waitcnt lgkmcnt(6)
    v_mfma_f32_16x16x32_bf16 v[216:219], v[28:31], v[96:99], v[216:219]
    v_mfma_f32_16x16x32_bf16 v[220:223], v[28:31], v[100:103], v[220:223]
    ds_read_b128 v[24:27], v10 offset:45056
    s_waitcnt lgkmcnt(6)
    v_mfma_f32_16x16x32_bf16 v[192:195], v[32:35], v[104:107], v[192:195]
    buffer_load_dwordx4 v[140:143], v8, s[52:55], s64 offen offset:3072 sc1
    s_add_u32 s64, s64, 4096
    v_mfma_f32_16x16x32_bf16 v[196:199], v[32:35], v[108:111], v[196:199]
    ds_read_b128 v[28:31], v10 offset:46080
    s_waitcnt lgkmcnt(6)
    v_mfma_f32_16x16x32_bf16 v[200:203], v[36:39], v[104:107], v[200:203]
    v_mfma_f32_16x16x32_bf16 v[204:207], v[36:39], v[108:111], v[204:207]
    ds_read_b128 v[32:35], v10 offset:50176
    v_mfma_f32_16x16x32_bf16 v[48:51], v[12:15], v[104:107], v[48:51]
    buffer_load_dwordx4 v[144:147], v8, s[52:55], s64 offen offset:0 sc1
    s_add_u32 s46, s46, s75
    s_lshr_b32 s47, s46, 1
    v_mfma_f32_16x16x32_bf16 v[52:55], v[104:107], v[104:107], v[52:55]
    s_and_b32 s62, s5, 1
    s_lshl_b32 s46, s46, 1
    s_waitcnt lgkmcnt(6)
    v_mfma_f32_16x16x32_bf16 v[208:211], v[40:43], v[104:107], v[208:211]
    v_mfma_f32_16x16x32_bf16 v[212:215], v[40:43], v[108:111], v[212:215]
    ds_read_b128 v[36:39], v10 offset:51200
    v_mfma_f32_16x16x32_bf16 v[56:59], v[12:15], v[108:111], v[56:59]
    buffer_load_dwordx4 v[148:151], v8, s[52:55], s64 offen offset:1024 sc1
    s_waitcnt vmcnt(16)
    v_swap_b32 v114, v116
    v_swap_b32 v115, v117
    v_mfma_f32_16x16x32_bf16 v[60:63], v[108:111], v[108:111], v[60:63]
    s_add_u32 s46, s46, s62
    s_lshl_b32 s46, s46, 9
    s_waitcnt lgkmcnt(6)
    v_mfma_f32_16x16x32_bf16 v[216:219], v[44:47], v[104:107], v[216:219]
    v_mfma_f32_16x16x32_bf16 v[220:223], v[44:47], v[108:111], v[220:223]
    ds_read_b128 v[40:43], v10 offset:52224
    s_waitcnt lgkmcnt(6)
    v_mfma_f32_16x16x32_bf16 v[192:195], v[16:19], v[112:115], v[192:195]
    buffer_load_dwordx4 v[152:155], v8, s[52:55], s64 offen offset:2048 sc1
    v_mfma_f32_16x16x32_bf16 v[196:199], v[16:19], v[116:119], v[196:199]
    ds_read_b128 v[44:47], v10 offset:53248
    s_waitcnt lgkmcnt(6)
    v_mfma_f32_16x16x32_bf16 v[200:203], v[20:23], v[112:115], v[200:203]
    v_mfma_f32_16x16x32_bf16 v[204:207], v[20:23], v[116:119], v[204:207]
    s_waitcnt vmcnt(7)
    s_barrier
    ds_read_b128 v[16:19], v11 offset:0
    v_mfma_f32_16x16x32_bf16 v[48:51], v[12:15], v[112:115], v[48:51]
    buffer_load_dwordx4 v[156:159], v8, s[52:55], s64 offen offset:3072 sc1
    s_add_u32 s64, s64, 4096
    s_add_u32 s46, s46, 27262976
    s_lshl_b32 s47, s47, 1
    v_mfma_f32_16x16x32_bf16 v[52:55], v[112:115], v[112:115], v[52:55]
    s_add_u32 s47, s47, s62
    s_lshl_b32 s47, s47, 9
    s_waitcnt lgkmcnt(6)
    v_mfma_f32_16x16x32_bf16 v[208:211], v[24:27], v[112:115], v[208:211]
    v_mfma_f32_16x16x32_bf16 v[212:215], v[24:27], v[116:119], v[212:215]
    ds_read_b128 v[20:23], v11 offset:1024
    v_mfma_f32_16x16x32_bf16 v[56:59], v[12:15], v[116:119], v[56:59]
    s_add_u32 m0, s66, 86016
    s_add_u32 s60, s65, 86016
    buffer_load_dwordx4 v8, s[52:55], s60 offen offset:0 sc1 lds
    s_waitcnt vmcnt(17)
    v_swap_b32 v122, v124
    v_swap_b32 v123, v125
    v_mfma_f32_16x16x32_bf16 v[60:63], v[116:119], v[116:119], v[60:63]
    s_and_b32 s63, s75, 1
    s_lshl_b32 s61, s63, 8
    s_waitcnt lgkmcnt(6)
    v_mfma_f32_16x16x32_bf16 v[216:219], v[28:31], v[112:115], v[216:219]
    v_mfma_f32_16x16x32_bf16 v[220:223], v[28:31], v[116:119], v[220:223]
    ds_read_b128 v[24:27], v11 offset:2048
    s_waitcnt lgkmcnt(6)
    v_mfma_f32_16x16x32_bf16 v[192:195], v[32:35], v[120:123], v[192:195]
    buffer_load_dwordx4 v8, s[52:55], s60 offen offset:1024 sc1 lds
    v_mfma_f32_16x16x32_bf16 v[196:199], v[32:35], v[124:127], v[196:199]
    ds_read_b128 v[28:31], v11 offset:3072
    s_waitcnt lgkmcnt(6)
    v_mfma_f32_16x16x32_bf16 v[200:203], v[36:39], v[120:123], v[200:203]
    v_mfma_f32_16x16x32_bf16 v[204:207], v[36:39], v[124:127], v[204:207]
    ds_read_b128 v[32:35], v11 offset:7168
    v_mfma_f32_16x16x32_bf16 v[48:51], v[12:15], v[120:123], v[48:51]
    buffer_load_dwordx4 v8, s[52:55], s60 offen offset:2048 sc1 lds
    s_add_u32 s47, s47, s61
    s_add_u32 s47, s47, 28311552
    v_mfma_f32_16x16x32_bf16 v[52:55], v[120:123], v[120:123], v[52:55]
    s_mul_i32 s44, s44, 56
    s_lshr_b32 s61, s75, 1
    s_waitcnt lgkmcnt(6)
    v_mfma_f32_16x16x32_bf16 v[208:211], v[40:43], v[120:123], v[208:211]
    v_mfma_f32_16x16x32_bf16 v[212:215], v[40:43], v[124:127], v[212:215]
    ds_read_b128 v[36:39], v11 offset:8192
    v_mfma_f32_16x16x32_bf16 v[56:59], v[12:15], v[124:127], v[56:59]
    buffer_load_dwordx4 v8, s[52:55], s60 offen offset:3072 sc1 lds
    s_waitcnt vmcnt(10)
    v_swap_b32 v130, v132
    v_swap_b32 v131, v133
    v_mfma_f32_16x16x32_bf16 v[60:63], v[124:127], v[124:127], v[60:63]
    s_mul_i32 s61, s61, 7
    s_add_u32 s44, s44, s61
    s_waitcnt lgkmcnt(6)
    v_mfma_f32_16x16x32_bf16 v[216:219], v[44:47], v[120:123], v[216:219]
    v_mfma_f32_16x16x32_bf16 v[220:223], v[44:47], v[124:127], v[220:223]
    ds_read_b128 v[40:43], v11 offset:9216
    s_waitcnt lgkmcnt(6)
    v_mfma_f32_16x16x32_bf16 v[192:195], v[16:19], v[128:131], v[192:195]
    buffer_load_dwordx4 v[160:163], v8, s[52:55], s64 offen offset:0 sc1
    v_mfma_f32_16x16x32_bf16 v[196:199], v[16:19], v[132:135], v[196:199]
    ds_read_b128 v[44:47], v11 offset:10240
    s_waitcnt lgkmcnt(6)
    v_mfma_f32_16x16x32_bf16 v[200:203], v[20:23], v[128:131], v[200:203]
    v_mfma_f32_16x16x32_bf16 v[204:207], v[20:23], v[132:135], v[204:207]
    ds_read_b128 v[16:19], v11 offset:14336
    v_mfma_f32_16x16x32_bf16 v[48:51], v[12:15], v[128:131], v[48:51]
    buffer_load_dwordx4 v[164:167], v8, s[52:55], s64 offen offset:1024 sc1
    s_lshl_b32 s44, s44, 12
    s_lshl_b32 s61, s62, 11
    v_mfma_f32_16x16x32_bf16 v[52:55], v[128:131], v[128:131], v[52:55]
    s_add_u32 s44, s44, s61
    s_add_u32 s44, s44, 6291456
    s_waitcnt lgkmcnt(6)
    v_mfma_f32_16x16x32_bf16 v[208:211], v[24:27], v[128:131], v[208:211]
    v_mfma_f32_16x16x32_bf16 v[212:215], v[24:27], v[132:135], v[212:215]
    ds_read_b128 v[20:23], v11 offset:15360
    v_mfma_f32_16x16x32_bf16 v[56:59], v[12:15], v[132:135], v[56:59]
    buffer_load_dwordx4 v[168:171], v8, s[52:55], s64 offen offset:2048 sc1
    s_waitcnt vmcnt(11)
    v_swap_b32 v138, v140
    v_swap_b32 v139, v141
    v_mfma_f32_16x16x32_bf16 v[60:63], v[132:135], v[132:135], v[60:63]
    s_lshl_b32 s61, s63, 9
    s_add_u32 s45, s44, s61
    s_waitcnt lgkmcnt(6)
    v_mfma_f32_16x16x32_bf16 v[216:219], v[28:31], v[128:131], v[216:219]
    v_mfma_f32_16x16x32_bf16 v[220:223], v[28:31], v[132:135], v[220:223]
    ds_read_b128 v[24:27], v11 offset:16384
    s_waitcnt lgkmcnt(6)
    v_mfma_f32_16x16x32_bf16 v[192:195], v[32:35], v[136:139], v[192:195]
    buffer_load_dwordx4 v[172:175], v8, s[52:55], s64 offen offset:3072 sc1
    s_add_u32 s64, s64, 4096
    v_mfma_f32_16x16x32_bf16 v[196:199], v[32:35], v[140:143], v[196:199]
    ds_read_b32 v224, v249 offset:0
    ds_read_b32 v225, v249 offset:1024
    ds_read_b32 v226, v249 offset:2048
    ds_read_b32 v227, v249 offset:3072
    ds_read_b128 v[28:31], v11 offset:17408
    s_waitcnt lgkmcnt(6)
    v_mfma_f32_16x16x32_bf16 v[200:203], v[36:39], v[136:139], v[200:203]
    v_mfma_f32_16x16x32_bf16 v[204:207], v[36:39], v[140:143], v[204:207]
    ds_read_b32 v228, v249 offset:4096
    ds_read_b32 v229, v249 offset:5120
    ds_read_b32 v230, v249 offset:6144
    ds_read_b32 v231, v249 offset:7168
    ds_read_b128 v[32:35], v11 offset:21504
    v_mfma_f32_16x16x32_bf16 v[48:51], v[12:15], v[136:139], v[48:51]
    buffer_load_dwordx4 v[176:179], v8, s[52:55], s64 offen offset:0 sc1
    v_mfma_f32_16x16x32_bf16 v[52:55], v[136:139], v[136:139], v[52:55]
    s_waitcnt lgkmcnt(6)
    v_mfma_f32_16x16x32_bf16 v[208:211], v[40:43], v[136:139], v[208:211]
    v_mfma_f32_16x16x32_bf16 v[212:215], v[40:43], v[140:143], v[212:215]
    ds_read_b32 v232, v249 offset:8192
    ds_read_b32 v233, v249 offset:9216
    ds_read_b32 v234, v249 offset:10240
    ds_read_b32 v235, v249 offset:11264
    ds_read_b128 v[36:39], v11 offset:22528
    v_mfma_f32_16x16x32_bf16 v[56:59], v[12:15], v[140:143], v[56:59]
    buffer_load_dwordx4 v[180:183], v8, s[52:55], s64 offen offset:1024 sc1
    s_waitcnt vmcnt(12)
    v_swap_b32 v146, v148
    v_swap_b32 v147, v149
    v_mfma_f32_16x16x32_bf16 v[60:63], v[140:143], v[140:143], v[60:63]
    s_waitcnt lgkmcnt(6)
    v_mfma_f32_16x16x32_bf16 v[216:219], v[44:47], v[136:139], v[216:219]
    v_mfma_f32_16x16x32_bf16 v[220:223], v[44:47], v[140:143], v[220:223]
    ds_read_b32 v236, v249 offset:12288
    ds_read_b32 v237, v249 offset:13312
    ds_read_b32 v238, v249 offset:14336
    ds_read_b32 v239, v249 offset:15360
    ds_read_b128 v[40:43], v11 offset:23552
    s_waitcnt lgkmcnt(6)
    v_mfma_f32_16x16x32_bf16 v[192:195], v[16:19], v[144:147], v[192:195]
    buffer_load_dwordx4 v[184:187], v8, s[52:55], s64 offen offset:2048 sc1
    v_mfma_f32_16x16x32_bf16 v[196:199], v[16:19], v[148:151], v[196:199]
    ds_read_b128 v[44:47], v11 offset:24576
    s_waitcnt lgkmcnt(6)
    v_mfma_f32_16x16x32_bf16 v[200:203], v[20:23], v[144:147], v[200:203]
    v_mfma_f32_16x16x32_bf16 v[204:207], v[20:23], v[148:151], v[204:207]
    s_waitcnt vmcnt(7)
    s_barrier
    ds_read_b128 v[16:19], v11 offset:28672
    v_mfma_f32_16x16x32_bf16 v[48:51], v[12:15], v[144:147], v[48:51]
    buffer_load_dwordx4 v[188:191], v8, s[52:55], s64 offen offset:3072 sc1
    s_add_u32 s64, s64, 4096
    s_add_u32 s45, s45, 24576
    s_mul_i32 s61, s63, 12288
    v_mfma_f32_16x16x32_bf16 v[52:55], v[144:147], v[144:147], v[52:55]
    s_add_u32 s44, s44, s61
    v_and_b32 v6, 1, v3
    s_waitcnt lgkmcnt(6)
    v_mfma_f32_16x16x32_bf16 v[208:211], v[24:27], v[144:147], v[208:211]
    v_mfma_f32_16x16x32_bf16 v[212:215], v[24:27], v[148:151], v[212:215]
    ds_read_b128 v[20:23], v11 offset:29696
    v_mfma_f32_16x16x32_bf16 v[56:59], v[12:15], v[148:151], v[56:59]
    s_add_u32 m0, s66, 4096
    s_add_u32 s60, s65, 4096
    buffer_load_dwordx4 v8, s[52:55], s60 offen offset:0 sc1 lds
    s_waitcnt vmcnt(13)
    v_swap_b32 v154, v156
    v_swap_b32 v155, v157
    v_mfma_f32_16x16x32_bf16 v[60:63], v[148:151], v[148:151], v[60:63]
    v_lshlrev_b32 v7, 10, v6
    v_lshl_add_u32 v7, v2, 4, v7
    s_waitcnt lgkmcnt(6)
    v_mfma_f32_16x16x32_bf16 v[216:219], v[28:31], v[144:147], v[216:219]
    v_mfma_f32_16x16x32_bf16 v[220:223], v[28:31], v[148:151], v[220:223]
    ds_read_b128 v[24:27], v11 offset:30720
    s_waitcnt lgkmcnt(6)
    v_mfma_f32_16x16x32_bf16 v[192:195], v[32:35], v[152:155], v[192:195]
    buffer_load_dwordx4 v8, s[52:55], s60 offen offset:1024 sc1 lds
    v_mfma_f32_16x16x32_bf16 v[196:199], v[32:35], v[156:159], v[196:199]
    ds_read_b128 v[28:31], v11 offset:31744
    s_waitcnt lgkmcnt(6)
    v_mfma_f32_16x16x32_bf16 v[200:203], v[36:39], v[152:155], v[200:203]
    v_mfma_f32_16x16x32_bf16 v[204:207], v[36:39], v[156:159], v[204:207]
    ds_read_b128 v[32:35], v11 offset:35840
    v_mfma_f32_16x16x32_bf16 v[48:51], v[12:15], v[152:155], v[48:51]
    buffer_load_dwordx4 v8, s[52:55], s60 offen offset:2048 sc1 lds
    v_lshrrev_b32 v250, 1, v3
    v_lshl_add_u32 v7, v250, 8, v7
    v_mfma_f32_16x16x32_bf16 v[52:55], v[152:155], v[152:155], v[52:55]
    v_lshlrev_b32 v250, 7, v250
    v_lshl_add_u32 v250, v2, 3, v250
    s_waitcnt lgkmcnt(6)
    v_mfma_f32_16x16x32_bf16 v[208:211], v[40:43], v[152:155], v[208:211]
    v_mfma_f32_16x16x32_bf16 v[212:215], v[40:43], v[156:159], v[212:215]
    ds_read_b128 v[36:39], v11 offset:36864
    v_mfma_f32_16x16x32_bf16 v[56:59], v[12:15], v[156:159], v[56:59]
    s_add_u32 m0, s66, 32768
    s_add_u32 s60, s65, 32768
    buffer_load_dwordx4 v8, s[52:55], s60 offen offset:0 sc1 lds
    s_waitcnt vmcnt(10)
    v_swap_b32 v162, v164
    v_swap_b32 v163, v165
    v_mfma_f32_16x16x32_bf16 v[60:63], v[156:159], v[156:159], v[60:63]
    v_lshl_add_u32 v250, v6, 2, v250
    s_lshl_b32 s61, s62, 4
    s_waitcnt lgkmcnt(6)
    v_mfma_f32_16x16x32_bf16 v[216:219], v[44:47], v[152:155], v[216:219]
    v_mfma_f32_16x16x32_bf16 v[220:223], v[44:47], v[156:159], v[220:223]
    ds_read_b128 v[40:43], v11 offset:37888
    s_waitcnt lgkmcnt(6)
    v_mfma_f32_16x16x32_bf16 v[192:195], v[16:19], v[160:163], v[192:195]
    buffer_load_dwordx4 v8, s[52:55], s60 offen offset:1024 sc1 lds
    v_mfma_f32_16x16x32_bf16 v[196:199], v[16:19], v[164:167], v[196:199]
    v_add_f32 v224, v224, v232
    v_add_f32 v225, v225, v233
    v_add_f32 v226, v226, v234
    v_add_f32 v227, v227, v235
    v_add_f32 v228, v228, v236
    v_add_f32 v229, v229, v237
    v_add_f32 v230, v230, v238
    v_add_f32 v231, v231, v239
    ds_read_b128 v[44:47], v11 offset:38912
    s_waitcnt lgkmcnt(6)
    v_mfma_f32_16x16x32_bf16 v[200:203], v[20:23], v[160:163], v[200:203]
    v_mfma_f32_16x16x32_bf16 v[204:207], v[20:23], v[164:167], v[204:207]
    v_add_f32 v224, v224, v228
    v_add_f32 v225, v225, v229
    v_add_f32 v226, v226, v230
    v_add_f32 v227, v227, v231
    ds_read_b128 v[16:19], v11 offset:43008
    v_mfma_f32_16x16x32_bf16 v[48:51], v[12:15], v[160:163], v[48:51]
    buffer_load_dwordx4 v8, s[52:55], s60 offen offset:2048 sc1 lds
    v_mfma_f32_16x16x32_bf16 v[52:55], v[160:163], v[160:163], v[52:55]
    s_waitcnt lgkmcnt(6)
    v_mfma_f32_16x16x32_bf16 v[208:211], v[24:27], v[160:163], v[208:211]
    v_mfma_f32_16x16x32_bf16 v[212:215], v[24:27], v[164:167], v[212:215]
    v_add_f32 v224, v224, v226
    v_add_f32 v225, v225, v227
    ds_read_b128 v[20:23], v11 offset:44032
    v_mfma_f32_16x16x32_bf16 v[56:59], v[12:15], v[164:167], v[56:59]
    s_add_u32 m0, s66, 61440
    s_add_u32 s60, s65, 61440
    buffer_load_dwordx4 v8, s[52:55], s60 offen offset:0 sc1 lds
    s_waitcnt vmcnt(11)
    v_swap_b32 v170, v172
    v_swap_b32 v171, v173
    v_mfma_f32_16x16x32_bf16 v[60:63], v[164:167], v[164:167], v[60:63]
    s_waitcnt lgkmcnt(6)
    v_mfma_f32_16x16x32_bf16 v[216:219], v[28:31], v[160:163], v[216:219]
    v_mfma_f32_16x16x32_bf16 v[220:223], v[28:31], v[164:167], v[220:223]
    v_add_f32 v224, v224, v225
    ds_read_b128 v[24:27], v11 offset:45056
    s_waitcnt lgkmcnt(6)
    v_mfma_f32_16x16x32_bf16 v[192:195], v[32:35], v[168:171], v[192:195]
    buffer_load_dwordx4 v8, s[52:55], s60 offen offset:1024 sc1 lds
    v_mfma_f32_16x16x32_bf16 v[196:199], v[32:35], v[172:175], v[196:199]
    v_mul_f32 v224, 3216550459, v224
    ds_write_b32 v248, v224 offset:6144
    ds_read_b128 v[28:31], v11 offset:46080
    s_waitcnt lgkmcnt(6)
    v_mfma_f32_16x16x32_bf16 v[200:203], v[36:39], v[168:171], v[200:203]
    v_mfma_f32_16x16x32_bf16 v[204:207], v[36:39], v[172:175], v[204:207]
    ds_read_b128 v[32:35], v11 offset:50176
    v_mfma_f32_16x16x32_bf16 v[48:51], v[12:15], v[168:171], v[48:51]
    buffer_load_dwordx4 v8, s[52:55], s60 offen offset:2048 sc1 lds
    s_add_u32 s61, s61, 3
    s_add_u32 s63, s62, 5
    v_mfma_f32_16x16x32_bf16 v[52:55], v[168:171], v[168:171], v[52:55]
    v_mul_u32_u24 v6, s63, v6
    v_add_u32 v6, s61, v6
    s_waitcnt lgkmcnt(6)
    v_mfma_f32_16x16x32_bf16 v[208:211], v[40:43], v[168:171], v[208:211]
    v_mfma_f32_16x16x32_bf16 v[212:215], v[40:43], v[172:175], v[212:215]
    ds_read_b128 v[36:39], v11 offset:51200
    v_mfma_f32_16x16x32_bf16 v[56:59], v[12:15], v[172:175], v[56:59]
    s_add_u32 m0, s66, 90112
    s_add_u32 s60, s65, 90112
    buffer_load_dwordx4 v8, s[52:55], s60 offen offset:0 sc1 lds
    s_waitcnt vmcnt(12)
    v_swap_b32 v178, v180
    v_swap_b32 v179, v181
    v_mfma_f32_16x16x32_bf16 v[60:63], v[172:175], v[172:175], v[60:63]
    v_alignbit_b32 v251, s80, s80, v6
    s_mul_i32 s61, s62, 13
    s_waitcnt lgkmcnt(6)
    v_mfma_f32_16x16x32_bf16 v[216:219], v[44:47], v[168:171], v[216:219]
    v_mfma_f32_16x16x32_bf16 v[220:223], v[44:47], v[172:175], v[220:223]
    ds_read_b128 v[40:43], v11 offset:52224
    s_waitcnt lgkmcnt(6)
    v_mfma_f32_16x16x32_bf16 v[192:195], v[16:19], v[176:179], v[192:195]
    buffer_load_dwordx4 v8, s[52:55], s60 offen offset:1024 sc1 lds
    v_mfma_f32_16x16x32_bf16 v[196:199], v[16:19], v[180:183], v[196:199]
    ds_read_b128 v[44:47], v11 offset:53248
    s_waitcnt lgkmcnt(6)
    v_mfma_f32_16x16x32_bf16 v[200:203], v[20:23], v[176:179], v[200:203]
    v_mfma_f32_16x16x32_bf16 v[204:207], v[20:23], v[180:183], v[204:207]
    v_mfma_f32_16x16x32_bf16 v[48:51], v[12:15], v[176:179], v[48:51]
    buffer_load_dwordx4 v8, s[52:55], s60 offen offset:2048 sc1 lds
    v_mov_b32 v6, s61
    v_alignbit_b32 v252, s80, s80, v6
    v_mfma_f32_16x16x32_bf16 v[52:55], v[176:179], v[176:179], v[52:55]
    v_mov_b32 v253, v252
    v_mov_b32 v254, 3216550459
    s_waitcnt lgkmcnt(5)
    v_mfma_f32_16x16x32_bf16 v[208:211], v[24:27], v[176:179], v[208:211]
    v_mfma_f32_16x16x32_bf16 v[212:215], v[24:27], v[180:183], v[212:215]
    v_mfma_f32_16x16x32_bf16 v[56:59], v[12:15], v[180:183], v[56:59]
    s_waitcnt vmcnt(12)
    v_swap_b32 v186, v188
    v_swap_b32 v187, v189
    v_mfma_f32_16x16x32_bf16 v[60:63], v[180:183], v[180:183], v[60:63]
    v_lshlrev_b32 v6, 2, v1
    s_waitcnt lgkmcnt(4)
    v_mfma_f32_16x16x32_bf16 v[216:219], v[28:31], v[176:179], v[216:219]
    v_mfma_f32_16x16x32_bf16 v[220:223], v[28:31], v[180:183], v[220:223]
    s_waitcnt lgkmcnt(3)
    v_mfma_f32_16x16x32_bf16 v[192:195], v[32:35], v[184:187], v[192:195]
    v_mfma_f32_16x16x32_bf16 v[196:199], v[32:35], v[188:191], v[196:199]
    s_waitcnt lgkmcnt(2)
    v_mfma_f32_16x16x32_bf16 v[200:203], v[36:39], v[184:187], v[200:203]
    v_mfma_f32_16x16x32_bf16 v[204:207], v[36:39], v[188:191], v[204:207]
    v_mfma_f32_16x16x32_bf16 v[48:51], v[12:15], v[184:187], v[48:51]
    v_mfma_f32_16x16x32_bf16 v[52:55], v[184:187], v[184:187], v[52:55]
    s_waitcnt lgkmcnt(1)
    v_mfma_f32_16x16x32_bf16 v[208:211], v[40:43], v[184:187], v[208:211]
    v_mfma_f32_16x16x32_bf16 v[212:215], v[40:43], v[188:191], v[212:215]
    v_mfma_f32_16x16x32_bf16 v[56:59], v[12:15], v[188:191], v[56:59]
    v_mfma_f32_16x16x32_bf16 v[60:63], v[188:191], v[188:191], v[60:63]
    s_waitcnt lgkmcnt(0)
    v_mfma_f32_16x16x32_bf16 v[216:219], v[44:47], v[184:187], v[216:219]
    v_mfma_f32_16x16x32_bf16 v[220:223], v[44:47], v[188:191], v[220:223]
    s_waitcnt vmcnt(0)
    s_waitcnt lgkmcnt(0)
    s_barrier
    ds_read_b128 v[16:19], v4 offset:6144
    ds_read_b128 v[20:23], v4 offset:6656
    ds_read_b128 v[24:27], v4 offset:6208
    ds_read_b128 v[28:31], v4 offset:6720
    ds_read_b128 v[32:35], v4 offset:6272
    ds_read_b128 v[36:39], v4 offset:6784
    ds_read_b128 v[40:43], v4 offset:6336
    ds_read_b128 v[44:47], v4 offset:6848
    v_cndmask_b32 v52, v52, v53, s[20:21]
    v_cndmask_b32 v52, v52, v54, s[22:23]
    v_cndmask_b32 v52, v52, v55, s[40:41]
    ds_bpermute_b32 v52, v5, v52
    v_cndmask_b32 v60, v60, v61, s[20:21]
    v_cndmask_b32 v60, v60, v62, s[22:23]
    v_cndmask_b32 v60, v60, v63, s[40:41]
    ds_bpermute_b32 v60, v5, v60
    v_mul_f32 v48, 0x3b000000, v48
    v_mul_f32 v49, v48, v48
    v_mov_b32 v50, 0x3b000000
    v_mul_f32 v56, 0x3b000000, v56
    v_mul_f32 v57, v56, v56
    v_mov_b32 v58, 0x3b000000
    s_waitcnt lgkmcnt(0)
    v_fma_f32 v52, v52, v50, -v49
    v_max_f32 v52, 0, v52
    v_add_f32 v52, 0x3727c5ac, v52
    v_rsq_f32 v51, v52
    v_fma_f32 v60, v60, v58, -v57
    v_max_f32 v60, 0, v60
    v_add_f32 v60, 0x3727c5ac, v60
    v_rsq_f32 v59, v60
    v_mul_f32 v61, -v48, v51
    v_mul_f32 v60, v254, v51
    v_mul_f32 v63, -v56, v59
    v_mul_f32 v62, v254, v59
    v_pk_fma_f32 v[224:225], v[16:17], v[60:61], v[20:21] op_sel:[0,1,0] op_sel_hi:[1,1,1]
    v_pk_fma_f32 v[226:227], v[18:19], v[60:61], v[22:23] op_sel:[0,1,0] op_sel_hi:[1,1,1]
    v_pk_fma_f32 v[192:193], v[192:193], v[60:61], v[224:225] op_sel_hi:[1,0,1]
    v_pk_fma_f32 v[194:195], v[194:195], v[60:61], v[226:227] op_sel_hi:[1,0,1]
    v_exp_f32 v224, v192
    v_exp_f32 v225, v193
    v_exp_f32 v226, v194
    v_exp_f32 v227, v195
    v_pk_fma_f32 v[224:225], v[224:225], v[254:255], v[254:255] op_sel_hi:[1,0,0]
    v_pk_fma_f32 v[226:227], v[226:227], v[254:255], v[254:255] op_sel_hi:[1,0,0]
    v_rcp_f32 v224, v224
    v_rcp_f32 v225, v225
    v_rcp_f32 v226, v226
    v_rcp_f32 v227, v227
    v_pk_mul_f32 v[192:193], v[192:193], v[224:225]
    v_pk_mul_f32 v[194:195], v[194:195], v[226:227]
    v_cvt_pk_bf16_f32 v192, v192, v193
    v_cvt_pk_bf16_f32 v193, v194, v195
    v_pk_fma_f32 v[228:229], v[16:17], v[62:63], v[20:21] op_sel:[0,1,0] op_sel_hi:[1,1,1]
    v_pk_fma_f32 v[230:231], v[18:19], v[62:63], v[22:23] op_sel:[0,1,0] op_sel_hi:[1,1,1]
    v_pk_fma_f32 v[196:197], v[196:197], v[62:63], v[228:229] op_sel_hi:[1,0,1]
    v_pk_fma_f32 v[198:199], v[198:199], v[62:63], v[230:231] op_sel_hi:[1,0,1]
    v_exp_f32 v228, v196
    v_exp_f32 v229, v197
    v_exp_f32 v230, v198
    v_exp_f32 v231, v199
    v_pk_fma_f32 v[228:229], v[228:229], v[254:255], v[254:255] op_sel_hi:[1,0,0]
    v_pk_fma_f32 v[230:231], v[230:231], v[254:255], v[254:255] op_sel_hi:[1,0,0]
    v_rcp_f32 v228, v228
    v_rcp_f32 v229, v229
    v_rcp_f32 v230, v230
    v_rcp_f32 v231, v231
    v_pk_mul_f32 v[196:197], v[196:197], v[228:229]
    v_pk_mul_f32 v[198:199], v[198:199], v[230:231]
    v_cvt_pk_bf16_f32 v196, v196, v197
    v_cvt_pk_bf16_f32 v197, v198, v199
    v_pk_fma_f32 v[224:225], v[24:25], v[60:61], v[28:29] op_sel:[0,1,0] op_sel_hi:[1,1,1]
    v_pk_fma_f32 v[226:227], v[26:27], v[60:61], v[30:31] op_sel:[0,1,0] op_sel_hi:[1,1,1]
    v_pk_fma_f32 v[200:201], v[200:201], v[60:61], v[224:225] op_sel_hi:[1,0,1]
    v_pk_fma_f32 v[202:203], v[202:203], v[60:61], v[226:227] op_sel_hi:[1,0,1]
    v_exp_f32 v224, v200
    v_exp_f32 v225, v201
    v_exp_f32 v226, v202
    v_exp_f32 v227, v203
    v_pk_fma_f32 v[224:225], v[224:225], v[254:255], v[254:255] op_sel_hi:[1,0,0]
    v_pk_fma_f32 v[226:227], v[226:227], v[254:255], v[254:255] op_sel_hi:[1,0,0]
    v_rcp_f32 v224, v224
    v_rcp_f32 v225, v225
    v_rcp_f32 v226, v226
    v_rcp_f32 v227, v227
    v_pk_mul_f32 v[200:201], v[200:201], v[224:225]
    v_pk_mul_f32 v[202:203], v[202:203], v[226:227]
    v_cvt_pk_bf16_f32 v194, v200, v201
    v_cvt_pk_bf16_f32 v195, v202, v203
    buffer_store_dwordx4 v[192:195], v8, s[52:55], s44 offen offset:0 sc1
    v_bitop3_b32 v252, v252, v192, v193 bitop3:0x96
    v_bitop3_b32 v252, v252, v194, v195 bitop3:0x96
    v_pk_fma_f32 v[228:229], v[24:25], v[62:63], v[28:29] op_sel:[0,1,0] op_sel_hi:[1,1,1]
    v_pk_fma_f32 v[230:231], v[26:27], v[62:63], v[30:31] op_sel:[0,1,0] op_sel_hi:[1,1,1]
    v_pk_fma_f32 v[204:205], v[204:205], v[62:63], v[228:229] op_sel_hi:[1,0,1]
    v_pk_fma_f32 v[206:207], v[206:207], v[62:63], v[230:231] op_sel_hi:[1,0,1]
    v_exp_f32 v228, v204
    v_exp_f32 v229, v205
    v_exp_f32 v230, v206
    v_exp_f32 v231, v207
    v_pk_fma_f32 v[228:229], v[228:229], v[254:255], v[254:255] op_sel_hi:[1,0,0]
    v_pk_fma_f32 v[230:231], v[230:231], v[254:255], v[254:255] op_sel_hi:[1,0,0]
    v_rcp_f32 v228, v228
    v_rcp_f32 v229, v229
    v_rcp_f32 v230, v230
    v_rcp_f32 v231, v231
    v_pk_mul_f32 v[204:205], v[204:205], v[228:229]
    v_pk_mul_f32 v[206:207], v[206:207], v[230:231]
    v_cvt_pk_bf16_f32 v198, v204, v205
    v_cvt_pk_bf16_f32 v199, v206, v207
    buffer_store_dwordx4 v[196:199], v8, s[52:55], s44 offen offset:1024 sc1
    v_bitop3_b32 v252, v252, v196, v197 bitop3:0x96
    v_bitop3_b32 v252, v252, v198, v199 bitop3:0x96
    s_add_u32 s44, s44, 4096
    v_pk_fma_f32 v[224:225], v[32:33], v[60:61], v[36:37] op_sel:[0,1,0] op_sel_hi:[1,1,1]
    v_pk_fma_f32 v[226:227], v[34:35], v[60:61], v[38:39] op_sel:[0,1,0] op_sel_hi:[1,1,1]
    v_pk_fma_f32 v[208:209], v[208:209], v[60:61], v[224:225] op_sel_hi:[1,0,1]
    v_pk_fma_f32 v[210:211], v[210:211], v[60:61], v[226:227] op_sel_hi:[1,0,1]
    v_exp_f32 v224, v208
    v_exp_f32 v225, v209
    v_exp_f32 v226, v210
    v_exp_f32 v227, v211
    v_pk_fma_f32 v[224:225], v[224:225], v[254:255], v[254:255] op_sel_hi:[1,0,0]
    v_pk_fma_f32 v[226:227], v[226:227], v[254:255], v[254:255] op_sel_hi:[1,0,0]
    v_rcp_f32 v224, v224
    v_rcp_f32 v225, v225
    v_rcp_f32 v226, v226
    v_rcp_f32 v227, v227
    v_pk_mul_f32 v[208:209], v[208:209], v[224:225]
    v_pk_mul_f32 v[210:211], v[210:211], v[226:227]
    v_cvt_pk_bf16_f32 v208, v208, v209
    v_cvt_pk_bf16_f32 v209, v210, v211
    v_pk_fma_f32 v[228:229], v[32:33], v[62:63], v[36:37] op_sel:[0,1,0] op_sel_hi:[1,1,1]
    v_pk_fma_f32 v[230:231], v[34:35], v[62:63], v[38:39] op_sel:[0,1,0] op_sel_hi:[1,1,1]
    v_pk_fma_f32 v[212:213], v[212:213], v[62:63], v[228:229] op_sel_hi:[1,0,1]
    v_pk_fma_f32 v[214:215], v[214:215], v[62:63], v[230:231] op_sel_hi:[1,0,1]
    v_exp_f32 v228, v212
    v_exp_f32 v229, v213
    v_exp_f32 v230, v214
    v_exp_f32 v231, v215
    v_pk_fma_f32 v[228:229], v[228:229], v[254:255], v[254:255] op_sel_hi:[1,0,0]
    v_pk_fma_f32 v[230:231], v[230:231], v[254:255], v[254:255] op_sel_hi:[1,0,0]
    v_rcp_f32 v228, v228
    v_rcp_f32 v229, v229
    v_rcp_f32 v230, v230
    v_rcp_f32 v231, v231
    v_pk_mul_f32 v[212:213], v[212:213], v[228:229]
    v_pk_mul_f32 v[214:215], v[214:215], v[230:231]
    v_cvt_pk_bf16_f32 v212, v212, v213
    v_cvt_pk_bf16_f32 v213, v214, v215
    ds_read_b128 v[16:19], v10 offset:4096
    ds_read_b128 v[20:23], v10 offset:5120
    ds_read_b128 v[24:27], v10 offset:6144
    ds_read_b128 v[28:31], v10 offset:11264
    ds_read_b128 v[32:35], v10 offset:12288
    ds_read_b128 v[36:39], v10 offset:13312
    v_pk_fma_f32 v[224:225], v[40:41], v[60:61], v[44:45] op_sel:[0,1,0] op_sel_hi:[1,1,1]
    v_pk_fma_f32 v[226:227], v[42:43], v[60:61], v[46:47] op_sel:[0,1,0] op_sel_hi:[1,1,1]
    v_pk_fma_f32 v[216:217], v[216:217], v[60:61], v[224:225] op_sel_hi:[1,0,1]
    v_pk_fma_f32 v[218:219], v[218:219], v[60:61], v[226:227] op_sel_hi:[1,0,1]
    v_exp_f32 v224, v216
    v_exp_f32 v225, v217
    v_exp_f32 v226, v218
    v_exp_f32 v227, v219
    v_pk_fma_f32 v[224:225], v[224:225], v[254:255], v[254:255] op_sel_hi:[1,0,0]
    v_pk_fma_f32 v[226:227], v[226:227], v[254:255], v[254:255] op_sel_hi:[1,0,0]
    v_rcp_f32 v224, v224
    v_rcp_f32 v225, v225
    v_rcp_f32 v226, v226
    v_rcp_f32 v227, v227
    v_pk_mul_f32 v[216:217], v[216:217], v[224:225]
    v_pk_mul_f32 v[218:219], v[218:219], v[226:227]
    v_cvt_pk_bf16_f32 v210, v216, v217
    v_cvt_pk_bf16_f32 v211, v218, v219
    buffer_store_dwordx4 v[208:211], v8, s[52:55], s44 offen offset:0 sc1
    v_bitop3_b32 v252, v252, v208, v209 bitop3:0x96
    v_bitop3_b32 v252, v252, v210, v211 bitop3:0x96
    v_pk_fma_f32 v[228:229], v[40:41], v[62:63], v[44:45] op_sel:[0,1,0] op_sel_hi:[1,1,1]
    v_pk_fma_f32 v[230:231], v[42:43], v[62:63], v[46:47] op_sel:[0,1,0] op_sel_hi:[1,1,1]
    v_pk_fma_f32 v[220:221], v[220:221], v[62:63], v[228:229] op_sel_hi:[1,0,1]
    v_pk_fma_f32 v[222:223], v[222:223], v[62:63], v[230:231] op_sel_hi:[1,0,1]
    v_exp_f32 v228, v220
    v_exp_f32 v229, v221
    v_exp_f32 v230, v222
    v_exp_f32 v231, v223
    v_pk_fma_f32 v[228:229], v[228:229], v[254:255], v[254:255] op_sel_hi:[1,0,0]
    v_pk_fma_f32 v[230:231], v[230:231], v[254:255], v[254:255] op_sel_hi:[1,0,0]
    v_rcp_f32 v228, v228
    v_rcp_f32 v229, v229
    v_rcp_f32 v230, v230
    v_rcp_f32 v231, v231
    v_pk_mul_f32 v[220:221], v[220:221], v[228:229]
    v_pk_mul_f32 v[222:223], v[222:223], v[230:231]
    v_cvt_pk_bf16_f32 v214, v220, v221
    v_cvt_pk_bf16_f32 v215, v222, v223
    buffer_store_dwordx4 v[212:215], v8, s[52:55], s44 offen offset:1024 sc1
    v_bitop3_b32 v252, v252, v212, v213 bitop3:0x96
    v_bitop3_b32 v252, v252, v214, v215 bitop3:0x96
    s_add_u32 s44, s44, 4096
    buffer_store_dword v252, v6, s[52:55], s46 offen sc1
    ds_read_b128 v[40:43], v10 offset:18432
    s_waitcnt lgkmcnt(6)
    v_mfma_f32_16x16x32_bf16 v[224:227], v[16:19], v[64:67], 0
    buffer_load_dwordx4 a[164:167], v9, s[52:55], s79 offen offset:1024 sc1
    v_mfma_f32_16x16x32_bf16 v[228:231], v[16:19], v[68:71], 0
    ds_read_b128 v[44:47], v10 offset:19456
    s_waitcnt lgkmcnt(6)
    v_mfma_f32_16x16x32_bf16 v[232:235], v[20:23], v[64:67], 0
    v_mfma_f32_16x16x32_bf16 v[236:239], v[20:23], v[68:71], 0
    ds_read_b128 v[16:19], v10 offset:20480
    s_waitcnt lgkmcnt(6)
    v_mfma_f32_16x16x32_bf16 v[240:243], v[24:27], v[64:67], 0
    buffer_load_dwordx4 a[168:171], v9, s[52:55], s79 offen offset:2048 sc1
    v_mfma_f32_16x16x32_bf16 v[244:247], v[24:27], v[68:71], 0
    ds_read_b128 v[20:23], v10 offset:25600
    s_waitcnt lgkmcnt(6)
    v_mfma_f32_16x16x32_bf16 v[224:227], v[28:31], v[72:75], v[224:227]
    v_mfma_f32_16x16x32_bf16 v[228:231], v[28:31], v[76:79], v[228:231]
    ds_read_b128 v[24:27], v10 offset:26624
    s_waitcnt lgkmcnt(6)
    v_mfma_f32_16x16x32_bf16 v[232:235], v[32:35], v[72:75], v[232:235]
    buffer_load_dwordx4 a[172:175], v9, s[52:55], s79 offen offset:3072 sc1
    s_add_u32 s79, s79, 4096
    s_cmp_eq_u32 s79, s97
    s_cselect_b32 s60, 57344, 0
    s_sub_u32 s79, s79, s60
    v_mfma_f32_16x16x32_bf16 v[236:239], v[32:35], v[76:79], v[236:239]
    ds_read_b128 v[28:31], v10 offset:27648
    s_waitcnt lgkmcnt(6)
    v_mfma_f32_16x16x32_bf16 v[240:243], v[36:39], v[72:75], v[240:243]
    v_mfma_f32_16x16x32_bf16 v[244:247], v[36:39], v[76:79], v[244:247]
    ds_read_b128 v[32:35], v10 offset:32768
    s_waitcnt lgkmcnt(6)
    v_mfma_f32_16x16x32_bf16 v[224:227], v[40:43], v[80:83], v[224:227]
    buffer_load_dwordx4 a[176:179], v9, s[52:55], s79 offen offset:0 sc1
    v_mfma_f32_16x16x32_bf16 v[228:231], v[40:43], v[84:87], v[228:231]
    ds_read_b128 v[36:39], v10 offset:33792
    s_waitcnt lgkmcnt(6)
    v_mfma_f32_16x16x32_bf16 v[232:235], v[44:47], v[80:83], v[232:235]
    v_mfma_f32_16x16x32_bf16 v[236:239], v[44:47], v[84:87], v[236:239]
    ds_read_b128 v[40:43], v10 offset:34816
    s_waitcnt lgkmcnt(6)
    v_mfma_f32_16x16x32_bf16 v[240:243], v[16:19], v[80:83], v[240:243]
    buffer_load_dwordx4 a[180:183], v9, s[52:55], s79 offen offset:1024 sc1
    v_mfma_f32_16x16x32_bf16 v[244:247], v[16:19], v[84:87], v[244:247]
    ds_read_b128 v[44:47], v10 offset:39936
    s_waitcnt lgkmcnt(6)
    v_mfma_f32_16x16x32_bf16 v[224:227], v[20:23], v[88:91], v[224:227]
    v_mfma_f32_16x16x32_bf16 v[228:231], v[20:23], v[92:95], v[228:231]
    ds_read_b128 v[16:19], v10 offset:40960
    s_waitcnt lgkmcnt(6)
    v_mfma_f32_16x16x32_bf16 v[232:235], v[24:27], v[88:91], v[232:235]
    buffer_load_dwordx4 a[184:187], v9, s[52:55], s79 offen offset:2048 sc1
    v_mfma_f32_16x16x32_bf16 v[236:239], v[24:27], v[92:95], v[236:239]
    ds_read_b128 v[20:23], v10 offset:41984
    s_waitcnt lgkmcnt(6)
    v_mfma_f32_16x16x32_bf16 v[240:243], v[28:31], v[88:91], v[240:243]
    v_mfma_f32_16x16x32_bf16 v[244:247], v[28:31], v[92:95], v[244:247]
    ds_read_b128 v[24:27], v10 offset:47104
    s_waitcnt lgkmcnt(6)
    v_mfma_f32_16x16x32_bf16 v[224:227], v[32:35], v[96:99], v[224:227]
    buffer_load_dwordx4 a[188:191], v9, s[52:55], s79 offen offset:3072 sc1
    s_add_u32 s79, s79, 4096
    s_cmp_eq_u32 s79, s97
    s_cselect_b32 s60, 57344, 0
    s_sub_u32 s79, s79, s60
    v_mfma_f32_16x16x32_bf16 v[228:231], v[32:35], v[100:103], v[228:231]
    ds_read_b128 v[28:31], v10 offset:48128
    s_waitcnt lgkmcnt(6)
    v_mfma_f32_16x16x32_bf16 v[232:235], v[36:39], v[96:99], v[232:235]
    v_mfma_f32_16x16x32_bf16 v[236:239], v[36:39], v[100:103], v[236:239]
    ds_read_b128 v[32:35], v10 offset:49152
    s_waitcnt lgkmcnt(6)
    v_mfma_f32_16x16x32_bf16 v[240:243], v[40:43], v[96:99], v[240:243]
    buffer_load_dwordx4 a[192:195], v9, s[52:55], s79 offen offset:0 sc1
    v_mfma_f32_16x16x32_bf16 v[244:247], v[40:43], v[100:103], v[244:247]
    ds_read_b128 v[36:39], v10 offset:54272
    s_waitcnt lgkmcnt(6)
    v_mfma_f32_16x16x32_bf16 v[224:227], v[44:47], v[104:107], v[224:227]
    v_mfma_f32_16x16x32_bf16 v[228:231], v[44:47], v[108:111], v[228:231]
    ds_read_b128 v[40:43], v10 offset:55296
    s_waitcnt lgkmcnt(6)
    v_mfma_f32_16x16x32_bf16 v[232:235], v[16:19], v[104:107], v[232:235]
    buffer_load_dwordx4 a[196:199], v9, s[52:55], s79 offen offset:1024 sc1
    v_mfma_f32_16x16x32_bf16 v[236:239], v[16:19], v[108:111], v[236:239]
    ds_read_b128 v[44:47], v10 offset:56320
    s_waitcnt lgkmcnt(6)
    v_mfma_f32_16x16x32_bf16 v[240:243], v[20:23], v[104:107], v[240:243]
    v_mfma_f32_16x16x32_bf16 v[244:247], v[20:23], v[108:111], v[244:247]
    ds_read_b128 v[16:19], v11 offset:4096
    s_waitcnt lgkmcnt(6)
    v_mfma_f32_16x16x32_bf16 v[224:227], v[24:27], v[112:115], v[224:227]
    buffer_load_dwordx4 a[200:203], v9, s[52:55], s79 offen offset:2048 sc1
    v_mfma_f32_16x16x32_bf16 v[228:231], v[24:27], v[116:119], v[228:231]
    ds_read_b128 v[20:23], v11 offset:5120
    s_waitcnt lgkmcnt(6)
    v_mfma_f32_16x16x32_bf16 v[232:235], v[28:31], v[112:115], v[232:235]
    v_mfma_f32_16x16x32_bf16 v[236:239], v[28:31], v[116:119], v[236:239]
    ds_read_b128 v[24:27], v11 offset:6144
    s_waitcnt lgkmcnt(6)
    v_mfma_f32_16x16x32_bf16 v[240:243], v[32:35], v[112:115], v[240:243]
    buffer_load_dwordx4 a[204:207], v9, s[52:55], s79 offen offset:3072 sc1
    s_add_u32 s79, s79, 4096
    s_cmp_eq_u32 s79, s97
    s_cselect_b32 s60, 57344, 0
    s_sub_u32 s79, s79, s60
    v_mfma_f32_16x16x32_bf16 v[244:247], v[32:35], v[116:119], v[244:247]
    ds_read_b128 v[28:31], v11 offset:11264
    s_waitcnt lgkmcnt(6)
    v_mfma_f32_16x16x32_bf16 v[224:227], v[36:39], v[120:123], v[224:227]
    v_mfma_f32_16x16x32_bf16 v[228:231], v[36:39], v[124:127], v[228:231]
    ds_read_b128 v[32:35], v11 offset:12288
    s_waitcnt lgkmcnt(6)
    v_mfma_f32_16x16x32_bf16 v[232:235], v[40:43], v[120:123], v[232:235]
    buffer_load_dwordx4 a[208:211], v9, s[52:55], s79 offen offset:0 sc1
    v_mfma_f32_16x16x32_bf16 v[236:239], v[40:43], v[124:127], v[236:239]
    ds_read_b128 v[36:39], v11 offset:13312
    s_waitcnt lgkmcnt(6)
    v_mfma_f32_16x16x32_bf16 v[240:243], v[44:47], v[120:123], v[240:243]
    v_mfma_f32_16x16x32_bf16 v[244:247], v[44:47], v[124:127], v[244:247]
    ds_read_b128 v[40:43], v11 offset:18432
    s_waitcnt lgkmcnt(6)
    v_mfma_f32_16x16x32_bf16 v[224:227], v[16:19], v[128:131], v[224:227]
    buffer_load_dwordx4 a[212:215], v9, s[52:55], s79 offen offset:1024 sc1
    v_mfma_f32_16x16x32_bf16 v[228:231], v[16:19], v[132:135], v[228:231]
    ds_read_b128 v[44:47], v11 offset:19456
    s_waitcnt lgkmcnt(6)
    v_mfma_f32_16x16x32_bf16 v[232:235], v[20:23], v[128:131], v[232:235]
    v_mfma_f32_16x16x32_bf16 v[236:239], v[20:23], v[132:135], v[236:239]
    ds_read_b128 v[16:19], v11 offset:20480
    s_waitcnt lgkmcnt(6)
    v_mfma_f32_16x16x32_bf16 v[240:243], v[24:27], v[128:131], v[240:243]
    buffer_load_dwordx4 a[216:219], v9, s[52:55], s79 offen offset:2048 sc1
    v_mfma_f32_16x16x32_bf16 v[244:247], v[24:27], v[132:135], v[244:247]
    ds_read_b128 v[20:23], v11 offset:25600
    s_waitcnt lgkmcnt(6)
    v_mfma_f32_16x16x32_bf16 v[224:227], v[28:31], v[136:139], v[224:227]
    v_mfma_f32_16x16x32_bf16 v[228:231], v[28:31], v[140:143], v[228:231]
    ds_read_b128 v[24:27], v11 offset:26624
    s_waitcnt lgkmcnt(6)
    v_mfma_f32_16x16x32_bf16 v[232:235], v[32:35], v[136:139], v[232:235]
    buffer_load_dwordx4 a[220:223], v9, s[52:55], s79 offen offset:3072 sc1
    s_add_u32 s79, s79, 4096
    s_cmp_eq_u32 s79, s97
    s_cselect_b32 s60, 57344, 0
    s_sub_u32 s79, s79, s60
    v_mfma_f32_16x16x32_bf16 v[236:239], v[32:35], v[140:143], v[236:239]
    ds_read_b128 v[28:31], v11 offset:27648
    s_waitcnt lgkmcnt(6)
    v_mfma_f32_16x16x32_bf16 v[240:243], v[36:39], v[136:139], v[240:243]
    v_mfma_f32_16x16x32_bf16 v[244:247], v[36:39], v[140:143], v[244:247]
    ds_read_b128 v[32:35], v11 offset:32768
    s_waitcnt lgkmcnt(6)
    v_mfma_f32_16x16x32_bf16 v[224:227], v[40:43], v[144:147], v[224:227]
    s_mul_i32 s78, s76, 56
    s_mul_i32 s61, s5, 14
    s_add_u32 s78, s78, s61
    s_lshl_b32 s78, s78, 12
    s_add_u32 s78, s78, 6291456
    s_lshl_b32 s16, s76, 2
    s_add_u32 s16, s16, s5
    s_lshl_b32 s15, s16, 11
    s_add_u32 s15, s15, 28311552
    s_lshl_b32 s16, s16, 12
    s_add_u32 s16, s16, 27262976
    s_mov_b32 s60, s80
    s_mov_b32 s61, s80
    s_lshr_b64 s[62:63], s[60:61], 13
    s_xor_b32 s20, s80, s62
    s_lshr_b64 s[62:63], s[60:61], 3
    s_mov_b32 s21, s62
    s_lshr_b64 s[62:63], s[60:61], 8
    s_xor_b32 s21, s21, s62
    s_lshr_b64 s[62:63], s[60:61], 19
    s_xor_b32 s21, s21, s62
    s_lshr_b64 s[62:63], s[60:61], 25
    s_xor_b32 s21, s21, s62
    s_lshl_b32 s60, s5, 10
    v_add_u32 v12, s60, v8
    v_add_u32 v13, 1024, v12
    v_add_u32 v14, 2048, v12
    v_add_u32 v15, 3072, v12
    v_and_b32 v13, 4095, v13
    v_and_b32 v14, 4095, v14
    v_and_b32 v15, 4095, v15
    v_lshlrev_b32 v9, 3, v1
    s_mov_b32 s19, 0
    buffer_load_dword v88, v6, s[52:55], s16 offen offset:0 sc1
    v_mfma_f32_16x16x32_bf16 v[228:231], v[40:43], v[148:151], v[228:231]
    ds_read_b128 v[36:39], v11 offset:33792
    s_waitcnt lgkmcnt(6)
    v_mfma_f32_16x16x32_bf16 v[232:235], v[44:47], v[144:147], v[232:235]
    buffer_load_dword v89, v6, s[52:55], s16 offen offset:512 sc1
    v_mfma_f32_16x16x32_bf16 v[236:239], v[44:47], v[148:151], v[236:239]
    ds_read_b128 v[40:43], v11 offset:34816
    s_waitcnt lgkmcnt(6)
    v_mfma_f32_16x16x32_bf16 v[240:243], v[16:19], v[144:147], v[240:243]
    s_add_u32 s18, s78, 0
    buffer_load_dwordx4 v[96:99], v12, s[52:55], s18 offen sc1
    v_mfma_f32_16x16x32_bf16 v[244:247], v[16:19], v[148:151], v[244:247]
    ds_read_b128 v[44:47], v11 offset:39936
    s_waitcnt lgkmcnt(6)
    v_mfma_f32_16x16x32_bf16 v[224:227], v[20:23], v[152:155], v[224:227]
    buffer_load_dwordx4 v[100:103], v13, s[52:55], s18 offen sc1
    v_mfma_f32_16x16x32_bf16 v[228:231], v[20:23], v[156:159], v[228:231]
    ds_read_b128 v[16:19], v11 offset:40960
    s_waitcnt lgkmcnt(6)
    v_mfma_f32_16x16x32_bf16 v[232:235], v[24:27], v[152:155], v[232:235]
    buffer_load_dwordx4 v[104:107], v14, s[52:55], s18 offen sc1
    v_mfma_f32_16x16x32_bf16 v[236:239], v[24:27], v[156:159], v[236:239]
    ds_read_b128 v[20:23], v11 offset:41984
    s_waitcnt lgkmcnt(6)
    v_mfma_f32_16x16x32_bf16 v[240:243], v[28:31], v[152:155], v[240:243]
    buffer_load_dwordx4 v[108:111], v15, s[52:55], s18 offen sc1
    v_mfma_f32_16x16x32_bf16 v[244:247], v[28:31], v[156:159], v[244:247]
    ds_read_b128 v[24:27], v11 offset:47104
    s_waitcnt lgkmcnt(6)
    v_mfma_f32_16x16x32_bf16 v[224:227], v[32:35], v[160:163], v[224:227]
    s_add_u32 s18, s78, 4096
    buffer_load_dwordx4 v[112:115], v12, s[52:55], s18 offen sc1
    v_mfma_f32_16x16x32_bf16 v[228:231], v[32:35], v[164:167], v[228:231]
    ds_read_b128 v[28:31], v11 offset:48128
    s_waitcnt lgkmcnt(6)
    v_mfma_f32_16x16x32_bf16 v[232:235], v[36:39], v[160:163], v[232:235]
    buffer_load_dwordx4 v[116:119], v13, s[52:55], s18 offen sc1
    v_mfma_f32_16x16x32_bf16 v[236:239], v[36:39], v[164:167], v[236:239]
    ds_read_b128 v[32:35], v11 offset:49152
    s_waitcnt lgkmcnt(6)
    v_mfma_f32_16x16x32_bf16 v[240:243], v[40:43], v[160:163], v[240:243]
    buffer_load_dwordx4 v[120:123], v14, s[52:55], s18 offen sc1
    v_mfma_f32_16x16x32_bf16 v[244:247], v[40:43], v[164:167], v[244:247]
    ds_read_b128 v[36:39], v11 offset:54272
    s_waitcnt lgkmcnt(6)
    v_mfma_f32_16x16x32_bf16 v[224:227], v[44:47], v[168:171], v[224:227]
    buffer_load_dwordx4 v[124:127], v15, s[52:55], s18 offen sc1
    v_mfma_f32_16x16x32_bf16 v[228:231], v[44:47], v[172:175], v[228:231]
    ds_read_b128 v[40:43], v11 offset:55296
    s_waitcnt lgkmcnt(6)
    v_mfma_f32_16x16x32_bf16 v[232:235], v[16:19], v[168:171], v[232:235]
    buffer_load_dword v90, v6, s[52:55], s16 offen offset:1024 sc1
    v_mfma_f32_16x16x32_bf16 v[236:239], v[16:19], v[172:175], v[236:239]
    ds_read_b128 v[44:47], v11 offset:56320
    s_waitcnt lgkmcnt(6)
    v_mfma_f32_16x16x32_bf16 v[240:243], v[20:23], v[168:171], v[240:243]
    buffer_load_dword v91, v6, s[52:55], s16 offen offset:1536 sc1
    v_mfma_f32_16x16x32_bf16 v[244:247], v[20:23], v[172:175], v[244:247]
    s_waitcnt lgkmcnt(5)
    v_mfma_f32_16x16x32_bf16 v[224:227], v[24:27], v[176:179], v[224:227]
    ds_read_b128 v[64:67], v4 offset:6400
    s_add_u32 s18, s78, 12288
    buffer_load_dwordx4 v[128:131], v12, s[52:55], s18 offen sc1
    v_mfma_f32_16x16x32_bf16 v[228:231], v[24:27], v[180:183], v[228:231]
    ds_read_b128 v[68:71], v4 offset:6912
    s_waitcnt lgkmcnt(4)
    v_mfma_f32_16x16x32_bf16 v[232:235], v[28:31], v[176:179], v[232:235]
    ds_read_b128 v[72:75], v4 offset:6464
    buffer_load_dwordx4 v[132:135], v13, s[52:55], s18 offen sc1
    v_mfma_f32_16x16x32_bf16 v[236:239], v[28:31], v[180:183], v[236:239]
    ds_read_b128 v[76:79], v4 offset:6976
    s_waitcnt lgkmcnt(3)
    v_mfma_f32_16x16x32_bf16 v[240:243], v[32:35], v[176:179], v[240:243]
    ds_read_b128 v[80:83], v4 offset:6528
    buffer_load_dwordx4 v[136:139], v14, s[52:55], s18 offen sc1
    v_mfma_f32_16x16x32_bf16 v[244:247], v[32:35], v[180:183], v[244:247]
    ds_read_b128 v[84:87], v4 offset:7040
    s_waitcnt lgkmcnt(2)
    v_mfma_f32_16x16x32_bf16 v[224:227], v[36:39], v[184:187], v[224:227]
    buffer_load_dwordx4 v[140:143], v15, s[52:55], s18 offen sc1
    v_mfma_f32_16x16x32_bf16 v[228:231], v[36:39], v[188:191], v[228:231]
    s_waitcnt lgkmcnt(1)
    v_mfma_f32_16x16x32_bf16 v[232:235], v[40:43], v[184:187], v[232:235]
    s_add_u32 s18, s78, 16384
    buffer_load_dwordx4 v[144:147], v12, s[52:55], s18 offen sc1
    v_mfma_f32_16x16x32_bf16 v[236:239], v[40:43], v[188:191], v[236:239]
    s_waitcnt lgkmcnt(0)
    v_mfma_f32_16x16x32_bf16 v[240:243], v[44:47], v[184:187], v[240:243]
    buffer_load_dwordx4 v[148:151], v13, s[52:55], s18 offen sc1
    v_mfma_f32_16x16x32_bf16 v[244:247], v[44:47], v[188:191], v[244:247]
    s_lshl_b32 s60, s77, 9
    s_add_u32 s60, s60, 16863232
    v_lshl_add_u32 v18, v1, 3, s60
    buffer_load_dwordx2 v[10:11], v18, s[52:55], 0 offen sc1
    buffer_load_dwordx2 v[16:17], v18, s[52:55], s12 offen sc1
    buffer_load_dwordx2 v[28:29], v18, s[52:55], s13 offen sc1
    buffer_load_dwordx2 v[30:31], v18, s[52:55], s14 offen sc1
    s_lshl_b32 s60, s76, 1
    s_lshr_b32 s61, s5, 1
    s_add_u32 s60, s60, s61
    s_lshl_b32 s60, s60, 15
    s_lshl_b32 s61, s77, 12
    s_add_u32 s60, s60, s61
    s_and_b32 s61, s5, 1
    s_lshl_b32 s61, s61, 3
    s_add_u32 s60, s60, s61
    s_add_u32 s60, s60, 4194304
    v_lshlrev_b32 v19, 9, v3
    v_lshl_add_u32 v19, v2, 4, v19
    buffer_load_dwordx2 v[20:21], v19, s[52:55], s60 offen offset:0 sc1
    buffer_load_dwordx2 v[22:23], v19, s[52:55], s60 offen offset:256 sc1
    buffer_load_dwordx2 v[24:25], v19, s[52:55], s60 offen offset:2048 sc1
    buffer_load_dwordx2 v[26:27], v19, s[52:55], s60 offen offset:2304 sc1
    buffer_load_dwordx4 v[152:155], v14, s[52:55], s18 offen sc1
    buffer_load_dwordx4 v[156:159], v15, s[52:55], s18 offen sc1
    s_waitcnt lgkmcnt(0)
    v_mov_b32 v184, v249
    v_pk_fma_f32 v[32:33], v[80:81], v[60:61], v[84:85] op_sel:[0,1,0] op_sel_hi:[1,1,1]
    v_pk_fma_f32 v[34:35], v[82:83], v[60:61], v[86:87] op_sel:[0,1,0] op_sel_hi:[1,1,1]
    v_pk_fma_f32 v[240:241], v[240:241], v[60:61], v[32:33] op_sel_hi:[1,0,1]
    v_pk_fma_f32 v[242:243], v[242:243], v[60:61], v[34:35] op_sel_hi:[1,0,1]
    v_exp_f32 v32, v240
    v_exp_f32 v33, v241
    v_exp_f32 v34, v242
    v_exp_f32 v35, v243
    v_pk_fma_f32 v[32:33], v[32:33], v[254:255], v[254:255] op_sel_hi:[1,0,0]
    v_pk_fma_f32 v[34:35], v[34:35], v[254:255], v[254:255] op_sel_hi:[1,0,0]
    v_rcp_f32 v32, v32
    v_rcp_f32 v33, v33
    v_rcp_f32 v34, v34
    v_rcp_f32 v35, v35
    v_pk_mul_f32 v[240:241], v[240:241], v[32:33]
    v_pk_mul_f32 v[242:243], v[242:243], v[34:35]
    v_cvt_pk_bf16_f32 v40, v240, v241
    v_cvt_pk_bf16_f32 v41, v242, v243
    v_pk_fma_f32 v[36:37], v[80:81], v[62:63], v[84:85] op_sel:[0,1,0] op_sel_hi:[1,1,1]
    v_pk_fma_f32 v[38:39], v[82:83], v[62:63], v[86:87] op_sel:[0,1,0] op_sel_hi:[1,1,1]
    v_pk_fma_f32 v[244:245], v[244:245], v[62:63], v[36:37] op_sel_hi:[1,0,1]
    v_pk_fma_f32 v[246:247], v[246:247], v[62:63], v[38:39] op_sel_hi:[1,0,1]
    v_exp_f32 v36, v244
    v_exp_f32 v37, v245
    v_exp_f32 v38, v246
    v_exp_f32 v39, v247
    v_pk_fma_f32 v[36:37], v[36:37], v[254:255], v[254:255] op_sel_hi:[1,0,0]
    v_pk_fma_f32 v[38:39], v[38:39], v[254:255], v[254:255] op_sel_hi:[1,0,0]
    v_rcp_f32 v36, v36
    v_rcp_f32 v37, v37
    v_rcp_f32 v38, v38
    v_rcp_f32 v39, v39
    v_pk_mul_f32 v[244:245], v[244:245], v[36:37]
    v_pk_mul_f32 v[246:247], v[246:247], v[38:39]
    v_cvt_pk_bf16_f32 v42, v244, v245
    v_cvt_pk_bf16_f32 v43, v246, v247
    s_nop 0
    v_permlane16_swap_b32 v40, v42
    v_permlane16_swap_b32 v41, v43
    buffer_store_dwordx4 v[40:43], v7, s[52:55], s45 offen sc1
    v_bitop3_b32 v251, v251, v40, v41 bitop3:0x96
    v_bitop3_b32 v251, v251, v42, v43 bitop3:0x96
    buffer_store_dword v251, v250, s[52:55], s47 offen sc1
    v_pk_fma_f32 v[32:33], v[64:65], v[60:61], v[68:69] op_sel:[0,1,0] op_sel_hi:[1,1,1]
    v_pk_fma_f32 v[34:35], v[66:67], v[60:61], v[70:71] op_sel:[0,1,0] op_sel_hi:[1,1,1]
    v_pk_fma_f32 v[224:225], v[224:225], v[60:61], v[32:33] op_sel_hi:[1,0,1]
    v_pk_fma_f32 v[226:227], v[226:227], v[60:61], v[34:35] op_sel_hi:[1,0,1]
    v_exp_f32 v32, v224
    v_exp_f32 v33, v225
    v_exp_f32 v34, v226
    v_exp_f32 v35, v227
    v_pk_fma_f32 v[32:33], v[32:33], v[254:255], v[254:255] op_sel_hi:[1,0,0]
    v_pk_fma_f32 v[34:35], v[34:35], v[254:255], v[254:255] op_sel_hi:[1,0,0]
    v_rcp_f32 v32, v32
    v_rcp_f32 v33, v33
    v_rcp_f32 v34, v34
    v_rcp_f32 v35, v35
    v_pk_mul_f32 v[224:225], v[224:225], v[32:33]
    v_pk_mul_f32 v[226:227], v[226:227], v[34:35]
    v_cvt_pk_bf16_f32 v224, v224, v225
    v_cvt_pk_bf16_f32 v225, v226, v227
    v_pk_fma_f32 v[36:37], v[64:65], v[62:63], v[68:69] op_sel:[0,1,0] op_sel_hi:[1,1,1]
    v_pk_fma_f32 v[38:39], v[66:67], v[62:63], v[70:71] op_sel:[0,1,0] op_sel_hi:[1,1,1]
    v_pk_fma_f32 v[228:229], v[228:229], v[62:63], v[36:37] op_sel_hi:[1,0,1]
    v_pk_fma_f32 v[230:231], v[230:231], v[62:63], v[38:39] op_sel_hi:[1,0,1]
    v_exp_f32 v36, v228
    v_exp_f32 v37, v229
    v_exp_f32 v38, v230
    v_exp_f32 v39, v231
    v_pk_fma_f32 v[36:37], v[36:37], v[254:255], v[254:255] op_sel_hi:[1,0,0]
    v_pk_fma_f32 v[38:39], v[38:39], v[254:255], v[254:255] op_sel_hi:[1,0,0]
    v_rcp_f32 v36, v36
    v_rcp_f32 v37, v37
    v_rcp_f32 v38, v38
    v_rcp_f32 v39, v39
    v_pk_mul_f32 v[228:229], v[228:229], v[36:37]
    v_pk_mul_f32 v[230:231], v[230:231], v[38:39]
    v_cvt_pk_bf16_f32 v228, v228, v229
    v_cvt_pk_bf16_f32 v229, v230, v231
    v_pk_fma_f32 v[32:33], v[72:73], v[60:61], v[76:77] op_sel:[0,1,0] op_sel_hi:[1,1,1]
    v_pk_fma_f32 v[34:35], v[74:75], v[60:61], v[78:79] op_sel:[0,1,0] op_sel_hi:[1,1,1]
    v_pk_fma_f32 v[232:233], v[232:233], v[60:61], v[32:33] op_sel_hi:[1,0,1]
    v_pk_fma_f32 v[234:235], v[234:235], v[60:61], v[34:35] op_sel_hi:[1,0,1]
    v_exp_f32 v32, v232
    v_exp_f32 v33, v233
    v_exp_f32 v34, v234
    v_exp_f32 v35, v235
    v_pk_fma_f32 v[32:33], v[32:33], v[254:255], v[254:255] op_sel_hi:[1,0,0]
    v_pk_fma_f32 v[34:35], v[34:35], v[254:255], v[254:255] op_sel_hi:[1,0,0]
    v_rcp_f32 v32, v32
    v_rcp_f32 v33, v33
    v_rcp_f32 v34, v34
    v_rcp_f32 v35, v35
    v_pk_mul_f32 v[232:233], v[232:233], v[32:33]
    v_pk_mul_f32 v[234:235], v[234:235], v[34:35]
    v_cvt_pk_bf16_f32 v226, v232, v233
    v_cvt_pk_bf16_f32 v227, v234, v235
    buffer_store_dwordx4 v[224:227], v8, s[52:55], s44 offen offset:0 sc1
    v_bitop3_b32 v253, v253, v224, v225 bitop3:0x96
    v_bitop3_b32 v253, v253, v226, v227 bitop3:0x96
    v_pk_fma_f32 v[36:37], v[72:73], v[62:63], v[76:77] op_sel:[0,1,0] op_sel_hi:[1,1,1]
    v_pk_fma_f32 v[38:39], v[74:75], v[62:63], v[78:79] op_sel:[0,1,0] op_sel_hi:[1,1,1]
    v_pk_fma_f32 v[236:237], v[236:237], v[62:63], v[36:37] op_sel_hi:[1,0,1]
    v_pk_fma_f32 v[238:239], v[238:239], v[62:63], v[38:39] op_sel_hi:[1,0,1]
    v_exp_f32 v36, v236
    v_exp_f32 v37, v237
    v_exp_f32 v38, v238
    v_exp_f32 v39, v239
    v_pk_fma_f32 v[36:37], v[36:37], v[254:255], v[254:255] op_sel_hi:[1,0,0]
    v_pk_fma_f32 v[38:39], v[38:39], v[254:255], v[254:255] op_sel_hi:[1,0,0]
    v_rcp_f32 v36, v36
    v_rcp_f32 v37, v37
    v_rcp_f32 v38, v38
    v_rcp_f32 v39, v39
    v_pk_mul_f32 v[236:237], v[236:237], v[36:37]
    v_pk_mul_f32 v[238:239], v[238:239], v[38:39]
    v_cvt_pk_bf16_f32 v230, v236, v237
    v_cvt_pk_bf16_f32 v231, v238, v239
    buffer_store_dwordx4 v[228:231], v8, s[52:55], s44 offen offset:1024 sc1
    v_bitop3_b32 v253, v253, v228, v229 bitop3:0x96
    v_bitop3_b32 v253, v253, v230, v231 bitop3:0x96
    buffer_store_dword v253, v6, s[52:55], s46 offen offset:256 sc1
    s_barrier
L_g2_go:
    s_waitcnt vmcnt(7)
    s_mov_b32 s62, 0
L_ver_g:
    v_max3_u32 v4, v11, v17, v29
    v_max_u32 v4, v4, v31
    v_min3_u32 v5, v11, v17, v29
    v_min_u32 v5, v5, v31
    v_cmp_ne_u32 vcc, s80, v4
    v_cmp_ne_u32 s[60:61], s80, v5
    s_nop 0
    s_or_b64 vcc, vcc, s[60:61]
    s_cbranch_vccz L_ver_g_ok
    s_add_u32 s62, s62, 1
    s_cmp_gt_u32 s62, 4194304
    s_cbranch_scc1 L_ver_g_ok
    buffer_load_dwordx2 v[10:11], v18, s[52:55], 0 offen sc1
    buffer_load_dwordx2 v[16:17], v18, s[52:55], s12 offen sc1
    buffer_load_dwordx2 v[28:29], v18, s[52:55], s13 offen sc1
    buffer_load_dwordx2 v[30:31], v18, s[52:55], s14 offen sc1
    s_waitcnt vmcnt(0)
    s_branch L_ver_g
L_ver_g_ok:
    v_add_f32 v4, v10, v16
    v_add_f32 v7, v28, v30
    v_add_f32 v4, v4, v7
    v_cvt_pk_bf16_f32 v4, v4, v4
    v_and_b32 v4, 0xffff0000, v4
    s_lshl_b32 s60, s5, 8
    s_add_u32 s60, s60, 0
    v_lshl_add_u32 v5, v1, 2, s60
    ds_write_b32 v5, v4
    v_lshl_add_u32 v5, v3, 5, s60
    ds_read_b128 a[224:227], v5 offset:0
    ds_read_b128 a[228:231], v5 offset:16
    ds_read_b128 a[232:235], v5 offset:128
    ds_read_b128 a[236:239], v5 offset:144
    s_waitcnt lgkmcnt(0)
    s_waitcnt vmcnt(27)
    v_bitop3_b32 v4, v88, v89, v96 bitop3:0x96
    v_bitop3_b32 v4, v4, v97, v98 bitop3:0x96
    v_bitop3_b32 v4, v4, v99, v100 bitop3:0x96
    v_bitop3_b32 v4, v4, v101, v102 bitop3:0x96
    v_bitop3_b32 v4, v4, v103, v104 bitop3:0x96
    v_bitop3_b32 v4, v4, v105, v106 bitop3:0x96
    v_bitop3_b32 v4, v4, v107, v108 bitop3:0x96
    v_bitop3_b32 v4, v4, v109, v110 bitop3:0x96
    v_xor_b32 v4, v4, v111
    s_waitcnt vmcnt(23)
    v_bitop3_b32 v4, v4, v112, v113 bitop3:0x96
    v_bitop3_b32 v4, v4, v114, v115 bitop3:0x96
    v_bitop3_b32 v4, v4, v116, v117 bitop3:0x96
    v_bitop3_b32 v4, v4, v118, v119 bitop3:0x96
    v_bitop3_b32 v4, v4, v120, v121 bitop3:0x96
    v_bitop3_b32 v4, v4, v122, v123 bitop3:0x96
    v_bitop3_b32 v4, v4, v124, v125 bitop3:0x96
    v_bitop3_b32 v4, v4, v126, v127 bitop3:0x96
    v_cmp_ne_u32 vcc, s20, v4
    s_cbranch_vccnz L_g2_fix0
L_g2_back0:
    v_mfma_f32_16x16x32_bf16 v[192:195], a[0:3], v[96:99], 0
    buffer_load_dword v160, v6, s[52:55], s16 offen offset:2048 sc1
    v_mfma_f32_16x16x32_bf16 v[196:199], a[4:7], v[96:99], 0
    v_mfma_f32_16x16x32_bf16 v[200:203], a[8:11], v[96:99], 0
    v_mfma_f32_16x16x32_bf16 v[204:207], a[12:15], v[96:99], 0
    buffer_load_dword v161, v6, s[52:55], s16 offen offset:2560 sc1
    v_mfma_f32_16x16x32_bf16 v[208:211], a[0:3], v[100:103], 0
    v_mfma_f32_16x16x32_bf16 v[212:215], a[4:7], v[100:103], 0
    v_mfma_f32_16x16x32_bf16 v[216:219], a[8:11], v[100:103], 0
    s_add_u32 s18, s78, 28672
    buffer_load_dwordx4 v[32:35], v12, s[52:55], s18 offen sc1
    v_mfma_f32_16x16x32_bf16 v[220:223], a[12:15], v[100:103], 0
    v_mfma_f32_16x16x32_bf16 v[224:227], a[0:3], v[104:107], 0
    v_mfma_f32_16x16x32_bf16 v[228:231], a[4:7], v[104:107], 0
    s_waitcnt vmcnt(20)
    v_bitop3_b32 v5, v90, v91, v128 bitop3:0x96
    v_mfma_f32_16x16x32_bf16 v[232:235], a[8:11], v[104:107], 0
    buffer_load_dwordx4 v[36:39], v13, s[52:55], s18 offen sc1
    v_bitop3_b32 v5, v5, v129, v130 bitop3:0x96
    v_bitop3_b32 v5, v5, v131, v132 bitop3:0x96
    v_mfma_f32_16x16x32_bf16 v[236:239], a[12:15], v[104:107], 0
    v_bitop3_b32 v5, v5, v133, v134 bitop3:0x96
    v_bitop3_b32 v5, v5, v135, v136 bitop3:0x96
    v_mfma_f32_16x16x32_bf16 v[240:243], a[0:3], v[108:111], 0
    v_bitop3_b32 v5, v5, v137, v138 bitop3:0x96
    v_bitop3_b32 v5, v5, v139, v140 bitop3:0x96
    v_mfma_f32_16x16x32_bf16 v[244:247], a[4:7], v[108:111], 0
    buffer_load_dwordx4 v[40:43], v14, s[52:55], s18 offen sc1
    v_bitop3_b32 v5, v5, v141, v142 bitop3:0x96
    v_xor_b32 v5, v5, v143
    v_mfma_f32_16x16x32_bf16 v[248:251], a[8:11], v[108:111], 0
    v_mfma_f32_16x16x32_bf16 v[252:255], a[12:15], v[108:111], 0
    v_mfma_f32_16x16x32_bf16 v[192:195], a[16:19], v[112:115], v[192:195]
    buffer_load_dwordx4 v[44:47], v15, s[52:55], s18 offen sc1
    v_mfma_f32_16x16x32_bf16 v[196:199], a[20:23], v[112:115], v[196:199]
    v_mfma_f32_16x16x32_bf16 v[200:203], a[24:27], v[112:115], v[200:203]
    v_mfma_f32_16x16x32_bf16 v[204:207], a[28:31], v[112:115], v[204:207]
    s_add_u32 s18, s78, 32768
    buffer_load_dwordx4 v[48:51], v12, s[52:55], s18 offen sc1
    v_mfma_f32_16x16x32_bf16 v[208:211], a[16:19], v[116:119], v[208:211]
    v_mfma_f32_16x16x32_bf16 v[212:215], a[20:23], v[116:119], v[212:215]
    v_mfma_f32_16x16x32_bf16 v[216:219], a[24:27], v[116:119], v[216:219]
    buffer_load_dwordx4 v[52:55], v13, s[52:55], s18 offen sc1
    v_mfma_f32_16x16x32_bf16 v[220:223], a[28:31], v[116:119], v[220:223]
    v_mfma_f32_16x16x32_bf16 v[224:227], a[16:19], v[120:123], v[224:227]
    v_mfma_f32_16x16x32_bf16 v[228:231], a[20:23], v[120:123], v[228:231]
    s_waitcnt vmcnt(13)
    v_bitop3_b32 v5, v5, v144, v145 bitop3:0x96
    v_mfma_f32_16x16x32_bf16 v[232:235], a[24:27], v[120:123], v[232:235]
    buffer_load_dwordx4 v[56:59], v14, s[52:55], s18 offen sc1
    v_bitop3_b32 v5, v5, v146, v147 bitop3:0x96
    v_bitop3_b32 v5, v5, v148, v149 bitop3:0x96
    v_mfma_f32_16x16x32_bf16 v[236:239], a[28:31], v[120:123], v[236:239]
    v_bitop3_b32 v5, v5, v150, v151 bitop3:0x96
    v_bitop3_b32 v5, v5, v152, v153 bitop3:0x96
    v_mfma_f32_16x16x32_bf16 v[240:243], a[16:19], v[124:127], v[240:243]
    v_bitop3_b32 v5, v5, v154, v155 bitop3:0x96
    v_bitop3_b32 v5, v5, v156, v157 bitop3:0x96
    v_mfma_f32_16x16x32_bf16 v[244:247], a[20:23], v[124:127], v[244:247]
    buffer_load_dwordx4 v[60:63], v15, s[52:55], s18 offen sc1
    v_bitop3_b32 v5, v5, v158, v159 bitop3:0x96
    v_cmp_ne_u32 vcc, s20, v5
    s_cbranch_vccnz L_g2_fix1
L_g2_back1:
    v_mfma_f32_16x16x32_bf16 v[248:251], a[24:27], v[124:127], v[248:251]
    v_mfma_f32_16x16x32_bf16 v[252:255], a[28:31], v[124:127], v[252:255]
    v_mfma_f32_16x16x32_bf16 v[192:195], a[48:51], v[128:131], v[192:195]
    buffer_load_dword v162, v6, s[52:55], s16 offen offset:3072 sc1
    v_mfma_f32_16x16x32_bf16 v[196:199], a[52:55], v[128:131], v[196:199]
    v_mfma_f32_16x16x32_bf16 v[200:203], a[56:59], v[128:131], v[200:203]
    v_mfma_f32_16x16x32_bf16 v[204:207], a[60:63], v[128:131], v[204:207]
    buffer_load_dword v163, v6, s[52:55], s16 offen offset:3584 sc1
    v_mfma_f32_16x16x32_bf16 v[208:211], a[48:51], v[132:135], v[208:211]
    v_mfma_f32_16x16x32_bf16 v[212:215], a[52:55], v[132:135], v[212:215]
    v_mfma_f32_16x16x32_bf16 v[216:219], a[56:59], v[132:135], v[216:219]
    s_add_u32 s18, s78, 40960
    buffer_load_dwordx4 v[64:67], v12, s[52:55], s18 offen sc1
    v_mfma_f32_16x16x32_bf16 v[220:223], a[60:63], v[132:135], v[220:223]
    v_mfma_f32_16x16x32_bf16 v[224:227], a[48:51], v[136:139], v[224:227]
    v_mfma_f32_16x16x32_bf16 v[228:231], a[52:55], v[136:139], v[228:231]
    s_waitcnt vmcnt(7)
    v_bitop3_b32 v4, v160, v161, v32 bitop3:0x96
    v_mfma_f32_16x16x32_bf16 v[232:235], a[56:59], v[136:139], v[232:235]
    buffer_load_dwordx4 v[68:71], v13, s[52:55], s18 offen sc1
    v_bitop3_b32 v4, v4, v33, v34 bitop3:0x96
    v_bitop3_b32 v4, v4, v35, v36 bitop3:0x96
    v_mfma_f32_16x16x32_bf16 v[236:239], a[60:63], v[136:139], v[236:239]
    v_bitop3_b32 v4, v4, v37, v38 bitop3:0x96
    v_bitop3_b32 v4, v4, v39, v40 bitop3:0x96
    v_mfma_f32_16x16x32_bf16 v[240:243], a[48:51], v[140:143], v[240:243]
    v_bitop3_b32 v4, v4, v41, v42 bitop3:0x96
    v_bitop3_b32 v4, v4, v43, v44 bitop3:0x96
    v_mfma_f32_16x16x32_bf16 v[244:247], a[52:55], v[140:143], v[244:247]
    buffer_load_dwordx4 v[72:75], v14, s[52:55], s18 offen sc1
    v_bitop3_b32 v4, v4, v45, v46 bitop3:0x96
    v_xor_b32 v4, v4, v47
    v_mfma_f32_16x16x32_bf16 v[248:251], a[56:59], v[140:143], v[248:251]
    v_mfma_f32_16x16x32_bf16 v[252:255], a[60:63], v[140:143], v[252:255]
    v_mfma_f32_16x16x32_bf16 v[192:195], a[64:67], v[144:147], v[192:195]
    buffer_load_dwordx4 v[76:79], v15, s[52:55], s18 offen sc1
    v_mfma_f32_16x16x32_bf16 v[196:199], a[68:71], v[144:147], v[196:199]
    v_mfma_f32_16x16x32_bf16 v[200:203], a[72:75], v[144:147], v[200:203]
    v_mfma_f32_16x16x32_bf16 v[204:207], a[76:79], v[144:147], v[204:207]
    s_add_u32 s18, s78, 45056
    buffer_load_dwordx4 v[80:83], v12, s[52:55], s18 offen sc1
    v_mfma_f32_16x16x32_bf16 v[208:211], a[64:67], v[148:151], v[208:211]
    v_mfma_f32_16x16x32_bf16 v[212:215], a[68:71], v[148:151], v[212:215]
    v_mfma_f32_16x16x32_bf16 v[216:219], a[72:75], v[148:151], v[216:219]
    buffer_load_dwordx4 v[84:87], v13, s[52:55], s18 offen sc1
    v_mfma_f32_16x16x32_bf16 v[220:223], a[76:79], v[148:151], v[220:223]
    v_mfma_f32_16x16x32_bf16 v[224:227], a[64:67], v[152:155], v[224:227]
    v_mfma_f32_16x16x32_bf16 v[228:231], a[68:71], v[152:155], v[228:231]
    s_waitcnt vmcnt(8)
    v_bitop3_b32 v4, v4, v48, v49 bitop3:0x96
    v_mfma_f32_16x16x32_bf16 v[232:235], a[72:75], v[152:155], v[232:235]
    buffer_load_dwordx4 v[88:91], v14, s[52:55], s18 offen sc1
    v_bitop3_b32 v4, v4, v50, v51 bitop3:0x96
    v_bitop3_b32 v4, v4, v52, v53 bitop3:0x96
    v_mfma_f32_16x16x32_bf16 v[236:239], a[76:79], v[152:155], v[236:239]
    v_bitop3_b32 v4, v4, v54, v55 bitop3:0x96
    v_bitop3_b32 v4, v4, v56, v57 bitop3:0x96
    v_mfma_f32_16x16x32_bf16 v[240:243], a[64:67], v[156:159], v[240:243]
    v_bitop3_b32 v4, v4, v58, v59 bitop3:0x96
    v_bitop3_b32 v4, v4, v60, v61 bitop3:0x96
    v_mfma_f32_16x16x32_bf16 v[244:247], a[68:71], v[156:159], v[244:247]
    buffer_load_dwordx4 v[92:95], v15, s[52:55], s18 offen sc1
    v_bitop3_b32 v4, v4, v62, v63 bitop3:0x96
    v_cmp_ne_u32 vcc, s20, v4
    s_cbranch_vccnz L_g2_fix2
L_g2_back2:
    v_mfma_f32_16x16x32_bf16 v[248:251], a[72:75], v[156:159], v[248:251]
    v_mfma_f32_16x16x32_bf16 v[252:255], a[76:79], v[156:159], v[252:255]
    v_mfma_f32_16x16x32_bf16 v[192:195], a[112:115], v[32:35], v[192:195]
    buffer_load_dword v164, v6, s[52:55], s16 offen offset:256 sc1
    v_mfma_f32_16x16x32_bf16 v[196:199], a[116:119], v[32:35], v[196:199]
    v_mfma_f32_16x16x32_bf16 v[200:203], a[120:123], v[32:35], v[200:203]
    v_mfma_f32_16x16x32_bf16 v[204:207], a[124:127], v[32:35], v[204:207]
    buffer_load_dword v165, v6, s[52:55], s16 offen offset:768 sc1
    v_mfma_f32_16x16x32_bf16 v[208:211], a[112:115], v[36:39], v[208:211]
    v_mfma_f32_16x16x32_bf16 v[212:215], a[116:119], v[36:39], v[212:215]
    v_mfma_f32_16x16x32_bf16 v[216:219], a[120:123], v[36:39], v[216:219]
    s_add_u32 s18, s78, 8192
    buffer_load_dwordx4 v[96:99], v12, s[52:55], s18 offen sc1
    v_mfma_f32_16x16x32_bf16 v[220:223], a[124:127], v[36:39], v[220:223]
    v_mfma_f32_16x16x32_bf16 v[224:227], a[112:115], v[40:43], v[224:227]
    v_mfma_f32_16x16x32_bf16 v[228:231], a[116:119], v[40:43], v[228:231]
    s_waitcnt vmcnt(7)
    v_bitop3_b32 v5, v162, v163, v64 bitop3:0x96
    v_mfma_f32_16x16x32_bf16 v[232:235], a[120:123], v[40:43], v[232:235]
    buffer_load_dwordx4 v[100:103], v13, s[52:55], s18 offen sc1
    v_bitop3_b32 v5, v5, v65, v66 bitop3:0x96
    v_bitop3_b32 v5, v5, v67, v68 bitop3:0x96
    v_mfma_f32_16x16x32_bf16 v[236:239], a[124:127], v[40:43], v[236:239]
    v_bitop3_b32 v5, v5, v69, v70 bitop3:0x96
    v_bitop3_b32 v5, v5, v71, v72 bitop3:0x96
    v_mfma_f32_16x16x32_bf16 v[240:243], a[112:115], v[44:47], v[240:243]
    v_bitop3_b32 v5, v5, v73, v74 bitop3:0x96
    v_bitop3_b32 v5, v5, v75, v76 bitop3:0x96
    v_mfma_f32_16x16x32_bf16 v[244:247], a[116:119], v[44:47], v[244:247]
    buffer_load_dwordx4 v[104:107], v14, s[52:55], s18 offen sc1
    v_bitop3_b32 v5, v5, v77, v78 bitop3:0x96
    v_xor_b32 v5, v5, v79
    v_mfma_f32_16x16x32_bf16 v[248:251], a[120:123], v[44:47], v[248:251]
    v_mfma_f32_16x16x32_bf16 v[252:255], a[124:127], v[44:47], v[252:255]
    v_mfma_f32_16x16x32_bf16 v[192:195], a[128:131], v[48:51], v[192:195]
    buffer_load_dwordx4 v[108:111], v15, s[52:55], s18 offen sc1
    v_mfma_f32_16x16x32_bf16 v[196:199], a[132:135], v[48:51], v[196:199]
    v_mfma_f32_16x16x32_bf16 v[200:203], a[136:139], v[48:51], v[200:203]
    v_mfma_f32_16x16x32_bf16 v[204:207], a[140:143], v[48:51], v[204:207]
    buffer_load_dword v166, v6, s[52:55], s16 offen offset:1280 sc1
    v_mfma_f32_16x16x32_bf16 v[208:211], a[128:131], v[52:55], v[208:211]
    v_mfma_f32_16x16x32_bf16 v[212:215], a[132:135], v[52:55], v[212:215]
    v_mfma_f32_16x16x32_bf16 v[216:219], a[136:139], v[52:55], v[216:219]
    buffer_load_dword v167, v6, s[52:55], s16 offen offset:1792 sc1
    v_mfma_f32_16x16x32_bf16 v[220:223], a[140:143], v[52:55], v[220:223]
    v_mfma_f32_16x16x32_bf16 v[224:227], a[128:131], v[56:59], v[224:227]
    v_mfma_f32_16x16x32_bf16 v[228:231], a[132:135], v[56:59], v[228:231]
    s_waitcnt vmcnt(8)
    v_bitop3_b32 v5, v5, v80, v81 bitop3:0x96
    v_mfma_f32_16x16x32_bf16 v[232:235], a[136:139], v[56:59], v[232:235]
    s_add_u32 s18, s78, 20480
    buffer_load_dwordx4 v[112:115], v12, s[52:55], s18 offen sc1
    v_bitop3_b32 v5, v5, v82, v83 bitop3:0x96
    v_bitop3_b32 v5, v5, v84, v85 bitop3:0x96
    v_mfma_f32_16x16x32_bf16 v[236:239], a[140:143], v[56:59], v[236:239]
    v_bitop3_b32 v5, v5, v86, v87 bitop3:0x96
    v_bitop3_b32 v5, v5, v88, v89 bitop3:0x96
    v_mfma_f32_16x16x32_bf16 v[240:243], a[128:131], v[60:63], v[240:243]
    v_bitop3_b32 v5, v5, v90, v91 bitop3:0x96
    v_bitop3_b32 v5, v5, v92, v93 bitop3:0x96
    v_mfma_f32_16x16x32_bf16 v[244:247], a[132:135], v[60:63], v[244:247]
    buffer_load_dwordx4 v[116:119], v13, s[52:55], s18 offen sc1
    v_bitop3_b32 v5, v5, v94, v95 bitop3:0x96
    v_cmp_ne_u32 vcc, s20, v5
    s_cbranch_vccnz L_g2_fix3
L_g2_back3:
    v_mfma_f32_16x16x32_bf16 v[248:251], a[136:139], v[60:63], v[248:251]
    v_mfma_f32_16x16x32_bf16 v[252:255], a[140:143], v[60:63], v[252:255]
    v_mfma_f32_16x16x32_bf16 v[192:195], a[160:163], v[64:67], v[192:195]
    buffer_load_dwordx4 v[120:123], v14, s[52:55], s18 offen sc1
    v_mfma_f32_16x16x32_bf16 v[196:199], a[164:167], v[64:67], v[196:199]
    v_mfma_f32_16x16x32_bf16 v[200:203], a[168:171], v[64:67], v[200:203]
    v_mfma_f32_16x16x32_bf16 v[204:207], a[172:175], v[64:67], v[204:207]
    buffer_load_dwordx4 v[124:127], v15, s[52:55], s18 offen sc1
    v_mfma_f32_16x16x32_bf16 v[208:211], a[160:163], v[68:71], v[208:211]
    v_mfma_f32_16x16x32_bf16 v[212:215], a[164:167], v[68:71], v[212:215]
    v_mfma_f32_16x16x32_bf16 v[216:219], a[168:171], v[68:71], v[216:219]
    buffer_load_dwordx2 v[168:169], v9, s[52:55], s15 offen offset:0 sc1
    v_mfma_f32_16x16x32_bf16 v[220:223], a[172:175], v[68:71], v[220:223]
    v_mfma_f32_16x16x32_bf16 v[224:227], a[160:163], v[72:75], v[224:227]
    v_mfma_f32_16x16x32_bf16 v[228:231], a[164:167], v[72:75], v[228:231]
    v_mfma_f32_16x16x32_bf16 v[232:235], a[168:171], v[72:75], v[232:235]
    buffer_load_dwordx2 v[170:171], v9, s[52:55], s15 offen offset:512 sc1
    v_mfma_f32_16x16x32_bf16 v[236:239], a[172:175], v[72:75], v[236:239]
    v_mfma_f32_16x16x32_bf16 v[240:243], a[160:163], v[76:79], v[240:243]
    v_mfma_f32_16x16x32_bf16 v[244:247], a[164:167], v[76:79], v[244:247]
    s_add_u32 s18, s78, 24576
    buffer_load_dwordx4 v[128:131], v12, s[52:55], s18 offen sc1
    v_mfma_f32_16x16x32_bf16 v[248:251], a[168:171], v[76:79], v[248:251]
    v_mfma_f32_16x16x32_bf16 v[252:255], a[172:175], v[76:79], v[252:255]
    v_mfma_f32_16x16x32_bf16 v[192:195], a[176:179], v[80:83], v[192:195]
    buffer_load_dwordx4 v[132:135], v13, s[52:55], s18 offen sc1
    v_mfma_f32_16x16x32_bf16 v[196:199], a[180:183], v[80:83], v[196:199]
    v_mfma_f32_16x16x32_bf16 v[200:203], a[184:187], v[80:83], v[200:203]
    v_mfma_f32_16x16x32_bf16 v[204:207], a[188:191], v[80:83], v[204:207]
    buffer_load_dwordx4 v[136:139], v14, s[52:55], s18 offen sc1
    v_mfma_f32_16x16x32_bf16 v[208:211], a[176:179], v[84:87], v[208:211]
    v_mfma_f32_16x16x32_bf16 v[212:215], a[180:183], v[84:87], v[212:215]
    v_mfma_f32_16x16x32_bf16 v[216:219], a[184:187], v[84:87], v[216:219]
    buffer_load_dwordx4 v[140:143], v15, s[52:55], s18 offen sc1
    v_mfma_f32_16x16x32_bf16 v[220:223], a[188:191], v[84:87], v[220:223]
    v_mfma_f32_16x16x32_bf16 v[224:227], a[176:179], v[88:91], v[224:227]
    v_mfma_f32_16x16x32_bf16 v[228:231], a[180:183], v[88:91], v[228:231]
    s_waitcnt vmcnt(12)
    v_bitop3_b32 v4, v164, v165, v96 bitop3:0x96
    v_mfma_f32_16x16x32_bf16 v[232:235], a[184:187], v[88:91], v[232:235]
    buffer_load_dword v172, v6, s[52:55], s16 offen offset:2304 sc1
    v_bitop3_b32 v4, v4, v97, v98 bitop3:0x96
    v_bitop3_b32 v4, v4, v99, v100 bitop3:0x96
    v_mfma_f32_16x16x32_bf16 v[236:239], a[188:191], v[88:91], v[236:239]
    v_bitop3_b32 v4, v4, v101, v102 bitop3:0x96
    v_bitop3_b32 v4, v4, v103, v104 bitop3:0x96
    v_mfma_f32_16x16x32_bf16 v[240:243], a[176:179], v[92:95], v[240:243]
    v_bitop3_b32 v4, v4, v105, v106 bitop3:0x96
    v_bitop3_b32 v4, v4, v107, v108 bitop3:0x96
    v_mfma_f32_16x16x32_bf16 v[244:247], a[180:183], v[92:95], v[244:247]
    buffer_load_dword v173, v6, s[52:55], s16 offen offset:2816 sc1
    v_bitop3_b32 v4, v4, v109, v110 bitop3:0x96
    v_xor_b32 v4, v4, v111
    v_mfma_f32_16x16x32_bf16 v[248:251], a[184:187], v[92:95], v[248:251]
    v_cmp_ne_u32 vcc, s20, v4
    s_cbranch_vccnz L_g2_fix4
L_g2_back4:
    v_mfma_f32_16x16x32_bf16 v[252:255], a[188:191], v[92:95], v[252:255]
    v_mfma_f32_16x16x32_bf16 v[192:195], a[32:35], v[96:99], v[192:195]
    s_add_u32 s18, s78, 36864
    buffer_load_dwordx4 v[144:147], v12, s[52:55], s18 offen sc1
    v_mfma_f32_16x16x32_bf16 v[196:199], a[36:39], v[96:99], v[196:199]
    v_mfma_f32_16x16x32_bf16 v[200:203], a[40:43], v[96:99], v[200:203]
    v_mfma_f32_16x16x32_bf16 v[204:207], a[44:47], v[96:99], v[204:207]
    buffer_load_dwordx4 v[148:151], v13, s[52:55], s18 offen sc1
    v_mfma_f32_16x16x32_bf16 v[208:211], a[32:35], v[100:103], v[208:211]
    v_mfma_f32_16x16x32_bf16 v[212:215], a[36:39], v[100:103], v[212:215]
    v_mfma_f32_16x16x32_bf16 v[216:219], a[40:43], v[100:103], v[216:219]
    buffer_load_dwordx4 v[152:155], v14, s[52:55], s18 offen sc1
    v_mfma_f32_16x16x32_bf16 v[220:223], a[44:47], v[100:103], v[220:223]
    v_mfma_f32_16x16x32_bf16 v[224:227], a[32:35], v[104:107], v[224:227]
    v_mfma_f32_16x16x32_bf16 v[228:231], a[36:39], v[104:107], v[228:231]
    s_waitcnt vmcnt(11)
    v_bitop3_b32 v5, v166, v167, v112 bitop3:0x96
    v_mfma_f32_16x16x32_bf16 v[232:235], a[40:43], v[104:107], v[232:235]
    buffer_load_dwordx4 v[156:159], v15, s[52:55], s18 offen sc1
    v_bitop3_b32 v5, v5, v113, v114 bitop3:0x96
    v_bitop3_b32 v5, v5, v115, v116 bitop3:0x96
    v_mfma_f32_16x16x32_bf16 v[236:239], a[44:47], v[104:107], v[236:239]
    v_bitop3_b32 v5, v5, v117, v118 bitop3:0x96
    v_bitop3_b32 v5, v5, v119, v120 bitop3:0x96
    v_mfma_f32_16x16x32_bf16 v[240:243], a[32:35], v[108:111], v[240:243]
    v_bitop3_b32 v5, v5, v121, v122 bitop3:0x96
    v_bitop3_b32 v5, v5, v123, v124 bitop3:0x96
    v_mfma_f32_16x16x32_bf16 v[244:247], a[36:39], v[108:111], v[244:247]
    buffer_load_dword v174, v6, s[52:55], s16 offen offset:3328 sc1
    v_bitop3_b32 v5, v5, v125, v126 bitop3:0x96
    v_xor_b32 v5, v5, v127
    v_mfma_f32_16x16x32_bf16 v[248:251], a[40:43], v[108:111], v[248:251]
    v_cmp_ne_u32 vcc, s20, v5
    s_cbranch_vccnz L_g2_fix5
L_g2_back5:
    v_mfma_f32_16x16x32_bf16 v[252:255], a[44:47], v[108:111], v[252:255]
    v_mfma_f32_16x16x32_bf16 v[192:195], a[80:83], v[112:115], v[192:195]
    buffer_load_dword v175, v6, s[52:55], s16 offen offset:3840 sc1
    v_mfma_f32_16x16x32_bf16 v[196:199], a[84:87], v[112:115], v[196:199]
    v_mfma_f32_16x16x32_bf16 v[200:203], a[88:91], v[112:115], v[200:203]
    v_mfma_f32_16x16x32_bf16 v[204:207], a[92:95], v[112:115], v[204:207]
    s_add_u32 s18, s78, 49152
    buffer_load_dwordx4 v[32:35], v12, s[52:55], s18 offen sc1
    v_mfma_f32_16x16x32_bf16 v[208:211], a[80:83], v[116:119], v[208:211]
    v_mfma_f32_16x16x32_bf16 v[212:215], a[84:87], v[116:119], v[212:215]
    v_mfma_f32_16x16x32_bf16 v[216:219], a[88:91], v[116:119], v[216:219]
    buffer_load_dwordx4 v[36:39], v13, s[52:55], s18 offen sc1
    v_mfma_f32_16x16x32_bf16 v[220:223], a[92:95], v[116:119], v[220:223]
    v_mfma_f32_16x16x32_bf16 v[224:227], a[80:83], v[120:123], v[224:227]
    v_mfma_f32_16x16x32_bf16 v[228:231], a[84:87], v[120:123], v[228:231]
    s_waitcnt vmcnt(10)
    v_bitop3_b32 v4, v168, v169, v170 bitop3:0x96
    v_mfma_f32_16x16x32_bf16 v[232:235], a[88:91], v[120:123], v[232:235]
    buffer_load_dwordx4 v[40:43], v14, s[52:55], s18 offen sc1
    v_bitop3_b32 v4, v4, v171, v128 bitop3:0x96
    v_bitop3_b32 v4, v4, v129, v130 bitop3:0x96
    v_mfma_f32_16x16x32_bf16 v[236:239], a[92:95], v[120:123], v[236:239]
    v_bitop3_b32 v4, v4, v131, v132 bitop3:0x96
    v_bitop3_b32 v4, v4, v133, v134 bitop3:0x96
    v_mfma_f32_16x16x32_bf16 v[240:243], a[80:83], v[124:127], v[240:243]
    v_bitop3_b32 v4, v4, v135, v136 bitop3:0x96
    v_bitop3_b32 v4, v4, v137, v138 bitop3:0x96
    v_mfma_f32_16x16x32_bf16 v[244:247], a[84:87], v[124:127], v[244:247]
    buffer_load_dwordx4 v[44:47], v15, s[52:55], s18 offen sc1
    v_bitop3_b32 v4, v4, v139, v140 bitop3:0x96
    v_bitop3_b32 v4, v4, v141, v142 bitop3:0x96
    v_mfma_f32_16x16x32_bf16 v[248:251], a[88:91], v[124:127], v[248:251]
    v_xor_b32 v4, v4, v143
    v_cmp_ne_u32 vcc, s21, v4
    s_cbranch_vccnz L_g2_fix6
L_g2_back6:
    v_mfma_f32_16x16x32_bf16 v[252:255], a[92:95], v[124:127], v[252:255]
    v_mfma_f32_16x16x32_bf16 v[192:195], a[96:99], v[128:131], v[192:195]
    buffer_load_dwordx2 v[176:177], v9, s[52:55], s15 offen offset:1024 sc1
    v_mfma_f32_16x16x32_bf16 v[196:199], a[100:103], v[128:131], v[196:199]
    v_mfma_f32_16x16x32_bf16 v[200:203], a[104:107], v[128:131], v[200:203]
    v_mfma_f32_16x16x32_bf16 v[204:207], a[108:111], v[128:131], v[204:207]
    buffer_load_dwordx2 v[178:179], v9, s[52:55], s15 offen offset:1536 sc1
    v_mfma_f32_16x16x32_bf16 v[208:211], a[96:99], v[132:135], v[208:211]
    v_mfma_f32_16x16x32_bf16 v[212:215], a[100:103], v[132:135], v[212:215]
    v_mfma_f32_16x16x32_bf16 v[216:219], a[104:107], v[132:135], v[216:219]
    s_add_u32 s18, s78, 53248
    buffer_load_dwordx4 v[48:51], v12, s[52:55], s18 offen sc1
    v_mfma_f32_16x16x32_bf16 v[220:223], a[108:111], v[132:135], v[220:223]
    v_mfma_f32_16x16x32_bf16 v[224:227], a[96:99], v[136:139], v[224:227]
    v_mfma_f32_16x16x32_bf16 v[228:231], a[100:103], v[136:139], v[228:231]
    s_waitcnt vmcnt(9)
    v_bitop3_b32 v5, v172, v173, v144 bitop3:0x96
    v_mfma_f32_16x16x32_bf16 v[232:235], a[104:107], v[136:139], v[232:235]
    buffer_load_dwordx4 v[52:55], v13, s[52:55], s18 offen sc1
    v_bitop3_b32 v5, v5, v145, v146 bitop3:0x96
    v_bitop3_b32 v5, v5, v147, v148 bitop3:0x96
    v_mfma_f32_16x16x32_bf16 v[236:239], a[108:111], v[136:139], v[236:239]
    v_bitop3_b32 v5, v5, v149, v150 bitop3:0x96
    v_bitop3_b32 v5, v5, v151, v152 bitop3:0x96
    v_mfma_f32_16x16x32_bf16 v[240:243], a[96:99], v[140:143], v[240:243]
    v_bitop3_b32 v5, v5, v153, v154 bitop3:0x96
    v_bitop3_b32 v5, v5, v155, v156 bitop3:0x96
    v_mfma_f32_16x16x32_bf16 v[244:247], a[100:103], v[140:143], v[244:247]
    buffer_load_dwordx4 v[56:59], v14, s[52:55], s18 offen sc1
    v_bitop3_b32 v5, v5, v157, v158 bitop3:0x96
    v_xor_b32 v5, v5, v159
    v_mfma_f32_16x16x32_bf16 v[248:251], a[104:107], v[140:143], v[248:251]
    v_cmp_ne_u32 vcc, s20, v5
    s_cbranch_vccnz L_g2_fix7
L_g2_back7:
    v_mfma_f32_16x16x32_bf16 v[252:255], a[108:111], v[140:143], v[252:255]
    v_mfma_f32_16x16x32_bf16 v[192:195], a[144:147], v[144:147], v[192:195]
    buffer_load_dwordx4 v[60:63], v15, s[52:55], s18 offen sc1
    v_mfma_f32_16x16x32_bf16 v[196:199], a[148:151], v[144:147], v[196:199]
    v_mfma_f32_16x16x32_bf16 v[200:203], a[152:155], v[144:147], v[200:203]
    v_mfma_f32_16x16x32_bf16 v[204:207], a[156:159], v[144:147], v[204:207]
    v_mfma_f32_16x16x32_bf16 v[208:211], a[144:147], v[148:151], v[208:211]
    v_mfma_f32_16x16x32_bf16 v[212:215], a[148:151], v[148:151], v[212:215]
    v_mfma_f32_16x16x32_bf16 v[216:219], a[152:155], v[148:151], v[216:219]
    v_mfma_f32_16x16x32_bf16 v[220:223], a[156:159], v[148:151], v[220:223]
    v_mfma_f32_16x16x32_bf16 v[224:227], a[144:147], v[152:155], v[224:227]
    v_mfma_f32_16x16x32_bf16 v[228:231], a[148:151], v[152:155], v[228:231]
    s_waitcnt vmcnt(6)
    v_bitop3_b32 v4, v174, v175, v32 bitop3:0x96
    v_mfma_f32_16x16x32_bf16 v[232:235], a[152:155], v[152:155], v[232:235]
    v_bitop3_b32 v4, v4, v33, v34 bitop3:0x96
    v_bitop3_b32 v4, v4, v35, v36 bitop3:0x96
    v_mfma_f32_16x16x32_bf16 v[236:239], a[156:159], v[152:155], v[236:239]
    v_bitop3_b32 v4, v4, v37, v38 bitop3:0x96
    v_bitop3_b32 v4, v4, v39, v40 bitop3:0x96
    v_mfma_f32_16x16x32_bf16 v[240:243], a[144:147], v[156:159], v[240:243]
    v_bitop3_b32 v4, v4, v41, v42 bitop3:0x96
    v_bitop3_b32 v4, v4, v43, v44 bitop3:0x96
    v_mfma_f32_16x16x32_bf16 v[244:247], a[148:151], v[156:159], v[244:247]
    v_bitop3_b32 v4, v4, v45, v46 bitop3:0x96
    v_xor_b32 v4, v4, v47
    v_mfma_f32_16x16x32_bf16 v[248:251], a[152:155], v[156:159], v[248:251]
    v_cmp_ne_u32 vcc, s20, v4
    s_cbranch_vccnz L_g2_fix8
L_g2_back8:
    v_mfma_f32_16x16x32_bf16 v[252:255], a[156:159], v[156:159], v[252:255]
    v_mfma_f32_16x16x32_bf16 v[192:195], a[192:195], v[32:35], v[192:195]
    s_add_u32 s60, s5, 1
    s_and_b32 s60, s60, 3
    s_mul_i32 s60, s60, 12288
    s_add_u32 s60, s60, 32768
    v_lshl_add_u32 v128, v1, 4, s60
    s_add_u32 s60, s5, 2
    s_and_b32 s60, s60, 3
    s_mul_i32 s60, s60, 12288
    s_add_u32 s60, s60, 36864
    v_lshl_add_u32 v129, v1, 4, s60
    s_add_u32 s60, s5, 3
    s_and_b32 s60, s60, 3
    s_mul_i32 s60, s60, 12288
    s_add_u32 s60, s60, 40960
    v_lshl_add_u32 v130, v1, 4, s60
    v_mfma_f32_16x16x32_bf16 v[196:199], a[196:199], v[32:35], v[196:199]
    s_mul_i32 s60, s5, 12288
    s_add_u32 s60, s60, 32768
    v_lshl_add_u32 v131, v1, 4, s60
    v_lshlrev_b32 v132, 10, v2
    v_lshl_add_u32 v132, v3, 4, v132
    v_mfma_f32_16x16x32_bf16 v[200:203], a[200:203], v[32:35], v[200:203]
    s_lshl_b32 s22, s76, 16
    s_lshl_b32 s61, s5, 14
    s_add_u32 s22, s22, s61
    s_lshl_b32 s61, s77, 7
    s_add_u32 s22, s22, s61
    v_accvgpr_read_b32 v96, a224
    v_accvgpr_read_b32 v97, a225
    v_mfma_f32_16x16x32_bf16 v[204:207], a[204:207], v[32:35], v[204:207]
    v_accvgpr_read_b32 v98, a226
    v_accvgpr_read_b32 v99, a227
    v_accvgpr_read_b32 v100, a228
    v_mfma_f32_16x16x32_bf16 v[208:211], a[192:195], v[36:39], v[208:211]
    v_accvgpr_read_b32 v101, a229
    v_accvgpr_read_b32 v102, a230
    v_accvgpr_read_b32 v103, a231
    v_mfma_f32_16x16x32_bf16 v[212:215], a[196:199], v[36:39], v[212:215]
    v_accvgpr_read_b32 v104, a232
    v_accvgpr_read_b32 v105, a233
    v_accvgpr_read_b32 v106, a234
    v_mfma_f32_16x16x32_bf16 v[216:219], a[200:203], v[36:39], v[216:219]
    v_accvgpr_read_b32 v107, a235
    v_accvgpr_read_b32 v108, a236
    v_accvgpr_read_b32 v109, a237
    v_mfma_f32_16x16x32_bf16 v[220:223], a[204:207], v[36:39], v[220:223]
    v_accvgpr_read_b32 v110, a238
    v_accvgpr_read_b32 v111, a239
    v_lshlrev_b32 v112, 16, v20
    v_mfma_f32_16x16x32_bf16 v[224:227], a[192:195], v[40:43], v[224:227]
    v_and_b32 v113, 0xffff0000, v20
    v_lshlrev_b32 v114, 16, v21
    v_and_b32 v115, 0xffff0000, v21
    v_mfma_f32_16x16x32_bf16 v[228:231], a[196:199], v[40:43], v[228:231]
    s_waitcnt vmcnt(0)
    v_bitop3_b32 v5, v176, v177, v178 bitop3:0x96
    v_mfma_f32_16x16x32_bf16 v[232:235], a[200:203], v[40:43], v[232:235]
    v_bitop3_b32 v5, v5, v179, v48 bitop3:0x96
    v_bitop3_b32 v5, v5, v49, v50 bitop3:0x96
    v_mfma_f32_16x16x32_bf16 v[236:239], a[204:207], v[40:43], v[236:239]
    v_bitop3_b32 v5, v5, v51, v52 bitop3:0x96
    v_bitop3_b32 v5, v5, v53, v54 bitop3:0x96
    v_mfma_f32_16x16x32_bf16 v[240:243], a[192:195], v[44:47], v[240:243]
    v_bitop3_b32 v5, v5, v55, v56 bitop3:0x96
    v_bitop3_b32 v5, v5, v57, v58 bitop3:0x96
    v_mfma_f32_16x16x32_bf16 v[244:247], a[196:199], v[44:47], v[244:247]
    v_bitop3_b32 v5, v5, v59, v60 bitop3:0x96
    v_bitop3_b32 v5, v5, v61, v62 bitop3:0x96
    v_mfma_f32_16x16x32_bf16 v[248:251], a[200:203], v[44:47], v[248:251]
    v_xor_b32 v5, v5, v63
    v_cmp_ne_u32 vcc, s21, v5
    s_cbranch_vccnz L_g2_fix9
L_g2_back9:
    v_mfma_f32_16x16x32_bf16 v[252:255], a[204:207], v[44:47], v[252:255]
    v_mfma_f32_16x16x32_bf16 v[208:211], a[208:211], v[52:55], v[208:211]
    v_lshlrev_b32 v116, 16, v22
    v_and_b32 v117, 0xffff0000, v22
    v_lshlrev_b32 v118, 16, v23
    v_mfma_f32_16x16x32_bf16 v[212:215], a[212:215], v[52:55], v[212:215]
    v_and_b32 v119, 0xffff0000, v23
    v_lshlrev_b32 v120, 16, v24
    v_and_b32 v121, 0xffff0000, v24
    v_mfma_f32_16x16x32_bf16 v[216:219], a[216:219], v[52:55], v[216:219]
    v_lshlrev_b32 v122, 16, v25
    v_and_b32 v123, 0xffff0000, v25
    v_lshlrev_b32 v124, 16, v26
    v_mfma_f32_16x16x32_bf16 v[220:223], a[220:223], v[52:55], v[220:223]
    v_and_b32 v125, 0xffff0000, v26
    v_lshlrev_b32 v126, 16, v27
    v_and_b32 v127, 0xffff0000, v27
    v_mfma_f32_16x16x32_bf16 v[224:227], a[208:211], v[56:59], v[224:227]
    v_mfma_f32_16x16x32_bf16 v[228:231], a[212:215], v[56:59], v[228:231]
    v_mfma_f32_16x16x32_bf16 v[232:235], a[216:219], v[56:59], v[232:235]
    v_mfma_f32_16x16x32_bf16 v[236:239], a[220:223], v[56:59], v[236:239]
    v_mfma_f32_16x16x32_bf16 v[240:243], a[208:211], v[60:63], v[240:243]
    ds_write_b128 v128, v[208:211] offset:0
    v_mfma_f32_16x16x32_bf16 v[244:247], a[212:215], v[60:63], v[244:247]
    ds_write_b128 v128, v[212:215] offset:1024
    v_mfma_f32_16x16x32_bf16 v[248:251], a[216:219], v[60:63], v[248:251]
    ds_write_b128 v128, v[216:219] offset:2048
    v_mfma_f32_16x16x32_bf16 v[252:255], a[220:223], v[60:63], v[252:255]
    ds_write_b128 v128, v[220:223] offset:3072
    v_mfma_f32_16x16x32_bf16 v[192:195], a[208:211], v[48:51], v[192:195]
    ds_write_b128 v129, v[224:227] offset:0
    v_mfma_f32_16x16x32_bf16 v[196:199], a[212:215], v[48:51], v[196:199]
    ds_write_b128 v129, v[228:231] offset:1024
    v_mfma_f32_16x16x32_bf16 v[200:203], a[216:219], v[48:51], v[200:203]
    ds_write_b128 v129, v[232:235] offset:2048
    v_mfma_f32_16x16x32_bf16 v[204:207], a[220:223], v[48:51], v[204:207]
    ds_write_b128 v129, v[236:239] offset:3072
    ds_write_b128 v130, v[240:243] offset:0
    ds_write_b128 v130, v[244:247] offset:1024
    ds_write_b128 v130, v[248:251] offset:2048
    ds_write_b128 v130, v[252:255] offset:3072
L_g2_giveup:
    s_waitcnt lgkmcnt(0)
    s_barrier
    ds_read_b128 v[136:139], v131 offset:0
    ds_read_b128 v[140:143], v131 offset:4096
    ds_read_b128 v[144:147], v131 offset:8192
    ds_read_b128 v[148:151], v131 offset:1024
    ds_read_b128 v[152:155], v131 offset:5120
    ds_read_b128 v[156:159], v131 offset:9216
    ds_read_b128 v[160:163], v131 offset:2048
    ds_read_b128 v[164:167], v131 offset:6144
    ds_read_b128 v[168:171], v131 offset:10240
    ds_read_b128 v[172:175], v131 offset:3072
    ds_read_b128 v[176:179], v131 offset:7168
    ds_read_b128 v[180:183], v131 offset:11264
    s_waitcnt lgkmcnt(9)
    v_pk_add_f32 v[136:137], v[136:137], v[140:141]
    v_pk_add_f32 v[192:193], v[192:193], v[144:145]
    v_pk_add_f32 v[138:139], v[138:139], v[142:143]
    v_pk_add_f32 v[194:195], v[194:195], v[146:147]
    v_pk_add_f32 v[136:137], v[136:137], v[192:193]
    v_pk_add_f32 v[138:139], v[138:139], v[194:195]
    v_pk_fma_f32 v[136:137], v[136:137], v[96:97], v[112:113]
    v_pk_fma_f32 v[138:139], v[138:139], v[98:99], v[114:115]
    v_cvt_pk_bf16_f32 v80, v136, v137
    v_cvt_pk_bf16_f32 v81, v138, v139
    s_waitcnt lgkmcnt(6)
    v_pk_add_f32 v[148:149], v[148:149], v[152:153]
    v_pk_add_f32 v[196:197], v[196:197], v[156:157]
    v_pk_add_f32 v[150:151], v[150:151], v[154:155]
    v_pk_add_f32 v[198:199], v[198:199], v[158:159]
    v_pk_add_f32 v[148:149], v[148:149], v[196:197]
    v_pk_add_f32 v[150:151], v[150:151], v[198:199]
    v_pk_fma_f32 v[148:149], v[148:149], v[100:101], v[116:117]
    v_pk_fma_f32 v[150:151], v[150:151], v[102:103], v[118:119]
    v_cvt_pk_bf16_f32 v82, v148, v149
    v_cvt_pk_bf16_f32 v83, v150, v151
    buffer_store_dwordx4 v[80:83], v132, s[48:51], s22 offen offset:0
    s_waitcnt lgkmcnt(3)
    v_pk_add_f32 v[160:161], v[160:161], v[164:165]
    v_pk_add_f32 v[200:201], v[200:201], v[168:169]
    v_pk_add_f32 v[162:163], v[162:163], v[166:167]
    v_pk_add_f32 v[202:203], v[202:203], v[170:171]
    v_pk_add_f32 v[160:161], v[160:161], v[200:201]
    v_pk_add_f32 v[162:163], v[162:163], v[202:203]
    v_pk_fma_f32 v[160:161], v[160:161], v[104:105], v[120:121]
    v_pk_fma_f32 v[162:163], v[162:163], v[106:107], v[122:123]
    v_cvt_pk_bf16_f32 v84, v160, v161
    v_cvt_pk_bf16_f32 v85, v162, v163
    s_waitcnt lgkmcnt(0)
    v_pk_add_f32 v[172:173], v[172:173], v[176:177]
    v_pk_add_f32 v[204:205], v[204:205], v[180:181]
    v_pk_add_f32 v[174:175], v[174:175], v[178:179]
    v_pk_add_f32 v[206:207], v[206:207], v[182:183]
    v_pk_add_f32 v[172:173], v[172:173], v[204:205]
    v_pk_add_f32 v[174:175], v[174:175], v[206:207]
    v_pk_fma_f32 v[172:173], v[172:173], v[108:109], v[124:125]
    v_pk_fma_f32 v[174:175], v[174:175], v[110:111], v[126:127]
    v_cvt_pk_bf16_f32 v86, v172, v173
    v_cvt_pk_bf16_f32 v87, v174, v175
    buffer_store_dwordx4 v[84:87], v132, s[48:51], s22 offen offset:64
    s_or_b32 s60, s2, s5
    s_cmp_lg_u32 s60, 0
    s_cbranch_scc1 L_tag_done
    v_mov_b32 v4, 29360128
    v_mov_b32 v6, s80
    v_mov_b32 v7, s81
    s_mov_b64 exec, 1
    buffer_store_dwordx2 v[6:7], v4, s[52:55], 0 offen
L_tag_done:
L_end_adaLN_cond__ssm_conv_h3__dense_activation_silu__prompt_kernel:
    s_endpgm
L_g2_fix0:
    s_add_u32 s19, s19, 1
    s_cmp_gt_u32 s19, 4194304
    s_cbranch_scc1 L_g2_back0
    s_waitcnt vmcnt(0)
    buffer_load_dword v88, v6, s[52:55], s16 offen offset:0 sc1
    buffer_load_dword v89, v6, s[52:55], s16 offen offset:512 sc1
    s_add_u32 s17, s78, 0
    buffer_load_dwordx4 v[96:99], v12, s[52:55], s17 offen sc1
    buffer_load_dwordx4 v[100:103], v13, s[52:55], s17 offen sc1
    buffer_load_dwordx4 v[104:107], v14, s[52:55], s17 offen sc1
    buffer_load_dwordx4 v[108:111], v15, s[52:55], s17 offen sc1
    s_add_u32 s17, s78, 4096
    buffer_load_dwordx4 v[112:115], v12, s[52:55], s17 offen sc1
    buffer_load_dwordx4 v[116:119], v13, s[52:55], s17 offen sc1
    buffer_load_dwordx4 v[120:123], v14, s[52:55], s17 offen sc1
    buffer_load_dwordx4 v[124:127], v15, s[52:55], s17 offen sc1
    s_waitcnt vmcnt(0)
    v_bitop3_b32 v4, v88, v89, v96 bitop3:0x96
    v_bitop3_b32 v4, v4, v97, v98 bitop3:0x96
    v_bitop3_b32 v4, v4, v99, v100 bitop3:0x96
    v_bitop3_b32 v4, v4, v101, v102 bitop3:0x96
    v_bitop3_b32 v4, v4, v103, v104 bitop3:0x96
    v_bitop3_b32 v4, v4, v105, v106 bitop3:0x96
    v_bitop3_b32 v4, v4, v107, v108 bitop3:0x96
    v_bitop3_b32 v4, v4, v109, v110 bitop3:0x96
    v_xor_b32 v4, v4, v111
    v_bitop3_b32 v4, v4, v112, v113 bitop3:0x96
    v_bitop3_b32 v4, v4, v114, v115 bitop3:0x96
    v_bitop3_b32 v4, v4, v116, v117 bitop3:0x96
    v_bitop3_b32 v4, v4, v118, v119 bitop3:0x96
    v_bitop3_b32 v4, v4, v120, v121 bitop3:0x96
    v_bitop3_b32 v4, v4, v122, v123 bitop3:0x96
    v_bitop3_b32 v4, v4, v124, v125 bitop3:0x96
    v_bitop3_b32 v4, v4, v126, v127 bitop3:0x96
    v_cmp_ne_u32 vcc, s20, v4
    s_cbranch_vccnz L_g2_fix0
    s_branch L_g2_back0
L_g2_fix1:
    s_add_u32 s19, s19, 1
    s_cmp_gt_u32 s19, 4194304
    s_cbranch_scc1 L_g2_back1
    s_waitcnt vmcnt(0)
    buffer_load_dword v90, v6, s[52:55], s16 offen offset:1024 sc1
    buffer_load_dword v91, v6, s[52:55], s16 offen offset:1536 sc1
    s_add_u32 s17, s78, 12288
    buffer_load_dwordx4 v[128:131], v12, s[52:55], s17 offen sc1
    buffer_load_dwordx4 v[132:135], v13, s[52:55], s17 offen sc1
    buffer_load_dwordx4 v[136:139], v14, s[52:55], s17 offen sc1
    buffer_load_dwordx4 v[140:143], v15, s[52:55], s17 offen sc1
    s_add_u32 s17, s78, 16384
    buffer_load_dwordx4 v[144:147], v12, s[52:55], s17 offen sc1
    buffer_load_dwordx4 v[148:151], v13, s[52:55], s17 offen sc1
    buffer_load_dwordx4 v[152:155], v14, s[52:55], s17 offen sc1
    buffer_load_dwordx4 v[156:159], v15, s[52:55], s17 offen sc1
    s_waitcnt vmcnt(0)
    v_bitop3_b32 v5, v90, v91, v128 bitop3:0x96
    v_bitop3_b32 v5, v5, v129, v130 bitop3:0x96
    v_bitop3_b32 v5, v5, v131, v132 bitop3:0x96
    v_bitop3_b32 v5, v5, v133, v134 bitop3:0x96
    v_bitop3_b32 v5, v5, v135, v136 bitop3:0x96
    v_bitop3_b32 v5, v5, v137, v138 bitop3:0x96
    v_bitop3_b32 v5, v5, v139, v140 bitop3:0x96
    v_bitop3_b32 v5, v5, v141, v142 bitop3:0x96
    v_xor_b32 v5, v5, v143
    v_bitop3_b32 v5, v5, v144, v145 bitop3:0x96
    v_bitop3_b32 v5, v5, v146, v147 bitop3:0x96
    v_bitop3_b32 v5, v5, v148, v149 bitop3:0x96
    v_bitop3_b32 v5, v5, v150, v151 bitop3:0x96
    v_bitop3_b32 v5, v5, v152, v153 bitop3:0x96
    v_bitop3_b32 v5, v5, v154, v155 bitop3:0x96
    v_bitop3_b32 v5, v5, v156, v157 bitop3:0x96
    v_bitop3_b32 v5, v5, v158, v159 bitop3:0x96
    v_cmp_ne_u32 vcc, s20, v5
    s_cbranch_vccnz L_g2_fix1
    s_branch L_g2_back1
L_g2_fix2:
    s_add_u32 s19, s19, 1
    s_cmp_gt_u32 s19, 4194304
    s_cbranch_scc1 L_g2_back2
    s_waitcnt vmcnt(0)
    buffer_load_dword v160, v6, s[52:55], s16 offen offset:2048 sc1
    buffer_load_dword v161, v6, s[52:55], s16 offen offset:2560 sc1
    s_add_u32 s17, s78, 28672
    buffer_load_dwordx4 v[32:35], v12, s[52:55], s17 offen sc1
    buffer_load_dwordx4 v[36:39], v13, s[52:55], s17 offen sc1
    buffer_load_dwordx4 v[40:43], v14, s[52:55], s17 offen sc1
    buffer_load_dwordx4 v[44:47], v15, s[52:55], s17 offen sc1
    s_add_u32 s17, s78, 32768
    buffer_load_dwordx4 v[48:51], v12, s[52:55], s17 offen sc1
    buffer_load_dwordx4 v[52:55], v13, s[52:55], s17 offen sc1
    buffer_load_dwordx4 v[56:59], v14, s[52:55], s17 offen sc1
    buffer_load_dwordx4 v[60:63], v15, s[52:55], s17 offen sc1
    s_waitcnt vmcnt(0)
    v_bitop3_b32 v4, v160, v161, v32 bitop3:0x96
    v_bitop3_b32 v4, v4, v33, v34 bitop3:0x96
    v_bitop3_b32 v4, v4, v35, v36 bitop3:0x96
    v_bitop3_b32 v4, v4, v37, v38 bitop3:0x96
    v_bitop3_b32 v4, v4, v39, v40 bitop3:0x96
    v_bitop3_b32 v4, v4, v41, v42 bitop3:0x96
    v_bitop3_b32 v4, v4, v43, v44 bitop3:0x96
    v_bitop3_b32 v4, v4, v45, v46 bitop3:0x96
    v_xor_b32 v4, v4, v47
    v_bitop3_b32 v4, v4, v48, v49 bitop3:0x96
    v_bitop3_b32 v4, v4, v50, v51 bitop3:0x96
    v_bitop3_b32 v4, v4, v52, v53 bitop3:0x96
    v_bitop3_b32 v4, v4, v54, v55 bitop3:0x96
    v_bitop3_b32 v4, v4, v56, v57 bitop3:0x96
    v_bitop3_b32 v4, v4, v58, v59 bitop3:0x96
    v_bitop3_b32 v4, v4, v60, v61 bitop3:0x96
    v_bitop3_b32 v4, v4, v62, v63 bitop3:0x96
    v_cmp_ne_u32 vcc, s20, v4
    s_cbranch_vccnz L_g2_fix2
    s_branch L_g2_back2
L_g2_fix3:
    s_add_u32 s19, s19, 1
    s_cmp_gt_u32 s19, 4194304
    s_cbranch_scc1 L_g2_back3
    s_waitcnt vmcnt(0)
    buffer_load_dword v162, v6, s[52:55], s16 offen offset:3072 sc1
    buffer_load_dword v163, v6, s[52:55], s16 offen offset:3584 sc1
    s_add_u32 s17, s78, 40960
    buffer_load_dwordx4 v[64:67], v12, s[52:55], s17 offen sc1
    buffer_load_dwordx4 v[68:71], v13, s[52:55], s17 offen sc1
    buffer_load_dwordx4 v[72:75], v14, s[52:55], s17 offen sc1
    buffer_load_dwordx4 v[76:79], v15, s[52:55], s17 offen sc1
    s_add_u32 s17, s78, 45056
    buffer_load_dwordx4 v[80:83], v12, s[52:55], s17 offen sc1
    buffer_load_dwordx4 v[84:87], v13, s[52:55], s17 offen sc1
    buffer_load_dwordx4 v[88:91], v14, s[52:55], s17 offen sc1
    buffer_load_dwordx4 v[92:95], v15, s[52:55], s17 offen sc1
    s_waitcnt vmcnt(0)
    v_bitop3_b32 v5, v162, v163, v64 bitop3:0x96
    v_bitop3_b32 v5, v5, v65, v66 bitop3:0x96
    v_bitop3_b32 v5, v5, v67, v68 bitop3:0x96
    v_bitop3_b32 v5, v5, v69, v70 bitop3:0x96
    v_bitop3_b32 v5, v5, v71, v72 bitop3:0x96
    v_bitop3_b32 v5, v5, v73, v74 bitop3:0x96
    v_bitop3_b32 v5, v5, v75, v76 bitop3:0x96
    v_bitop3_b32 v5, v5, v77, v78 bitop3:0x96
    v_xor_b32 v5, v5, v79
    v_bitop3_b32 v5, v5, v80, v81 bitop3:0x96
    v_bitop3_b32 v5, v5, v82, v83 bitop3:0x96
    v_bitop3_b32 v5, v5, v84, v85 bitop3:0x96
    v_bitop3_b32 v5, v5, v86, v87 bitop3:0x96
    v_bitop3_b32 v5, v5, v88, v89 bitop3:0x96
    v_bitop3_b32 v5, v5, v90, v91 bitop3:0x96
    v_bitop3_b32 v5, v5, v92, v93 bitop3:0x96
    v_bitop3_b32 v5, v5, v94, v95 bitop3:0x96
    v_cmp_ne_u32 vcc, s20, v5
    s_cbranch_vccnz L_g2_fix3
    s_branch L_g2_back3
L_g2_fix4:
    s_add_u32 s19, s19, 1
    s_cmp_gt_u32 s19, 4194304
    s_cbranch_scc1 L_g2_back4
    s_waitcnt vmcnt(0)
    buffer_load_dword v164, v6, s[52:55], s16 offen offset:256 sc1
    buffer_load_dword v165, v6, s[52:55], s16 offen offset:768 sc1
    s_add_u32 s17, s78, 8192
    buffer_load_dwordx4 v[96:99], v12, s[52:55], s17 offen sc1
    buffer_load_dwordx4 v[100:103], v13, s[52:55], s17 offen sc1
    buffer_load_dwordx4 v[104:107], v14, s[52:55], s17 offen sc1
    buffer_load_dwordx4 v[108:111], v15, s[52:55], s17 offen sc1
    s_waitcnt vmcnt(0)
    v_bitop3_b32 v4, v164, v165, v96 bitop3:0x96
    v_bitop3_b32 v4, v4, v97, v98 bitop3:0x96
    v_bitop3_b32 v4, v4, v99, v100 bitop3:0x96
    v_bitop3_b32 v4, v4, v101, v102 bitop3:0x96
    v_bitop3_b32 v4, v4, v103, v104 bitop3:0x96
    v_bitop3_b32 v4, v4, v105, v106 bitop3:0x96
    v_bitop3_b32 v4, v4, v107, v108 bitop3:0x96
    v_bitop3_b32 v4, v4, v109, v110 bitop3:0x96
    v_xor_b32 v4, v4, v111
    v_cmp_ne_u32 vcc, s20, v4
    s_cbranch_vccnz L_g2_fix4
    s_branch L_g2_back4
L_g2_fix5:
    s_add_u32 s19, s19, 1
    s_cmp_gt_u32 s19, 4194304
    s_cbranch_scc1 L_g2_back5
    s_waitcnt vmcnt(0)
    buffer_load_dword v166, v6, s[52:55], s16 offen offset:1280 sc1
    buffer_load_dword v167, v6, s[52:55], s16 offen offset:1792 sc1
    s_add_u32 s17, s78, 20480
    buffer_load_dwordx4 v[112:115], v12, s[52:55], s17 offen sc1
    buffer_load_dwordx4 v[116:119], v13, s[52:55], s17 offen sc1
    buffer_load_dwordx4 v[120:123], v14, s[52:55], s17 offen sc1
    buffer_load_dwordx4 v[124:127], v15, s[52:55], s17 offen sc1
    s_waitcnt vmcnt(0)
    v_bitop3_b32 v5, v166, v167, v112 bitop3:0x96
    v_bitop3_b32 v5, v5, v113, v114 bitop3:0x96
    v_bitop3_b32 v5, v5, v115, v116 bitop3:0x96
    v_bitop3_b32 v5, v5, v117, v118 bitop3:0x96
    v_bitop3_b32 v5, v5, v119, v120 bitop3:0x96
    v_bitop3_b32 v5, v5, v121, v122 bitop3:0x96
    v_bitop3_b32 v5, v5, v123, v124 bitop3:0x96
    v_bitop3_b32 v5, v5, v125, v126 bitop3:0x96
    v_xor_b32 v5, v5, v127
    v_cmp_ne_u32 vcc, s20, v5
    s_cbranch_vccnz L_g2_fix5
    s_branch L_g2_back5
L_g2_fix6:
    s_add_u32 s19, s19, 1
    s_cmp_gt_u32 s19, 4194304
    s_cbranch_scc1 L_g2_back6
    s_waitcnt vmcnt(0)
    buffer_load_dwordx2 v[168:169], v9, s[52:55], s15 offen offset:0 sc1
    buffer_load_dwordx2 v[170:171], v9, s[52:55], s15 offen offset:512 sc1
    s_add_u32 s17, s78, 24576
    buffer_load_dwordx4 v[128:131], v12, s[52:55], s17 offen sc1
    buffer_load_dwordx4 v[132:135], v13, s[52:55], s17 offen sc1
    buffer_load_dwordx4 v[136:139], v14, s[52:55], s17 offen sc1
    buffer_load_dwordx4 v[140:143], v15, s[52:55], s17 offen sc1
    s_waitcnt vmcnt(0)
    v_bitop3_b32 v4, v168, v169, v170 bitop3:0x96
    v_bitop3_b32 v4, v4, v171, v128 bitop3:0x96
    v_bitop3_b32 v4, v4, v129, v130 bitop3:0x96
    v_bitop3_b32 v4, v4, v131, v132 bitop3:0x96
    v_bitop3_b32 v4, v4, v133, v134 bitop3:0x96
    v_bitop3_b32 v4, v4, v135, v136 bitop3:0x96
    v_bitop3_b32 v4, v4, v137, v138 bitop3:0x96
    v_bitop3_b32 v4, v4, v139, v140 bitop3:0x96
    v_bitop3_b32 v4, v4, v141, v142 bitop3:0x96
    v_xor_b32 v4, v4, v143
    v_cmp_ne_u32 vcc, s21, v4
    s_cbranch_vccnz L_g2_fix6
    s_branch L_g2_back6
L_g2_fix7:
    s_add_u32 s19, s19, 1
    s_cmp_gt_u32 s19, 4194304
    s_cbranch_scc1 L_g2_back7
    s_waitcnt vmcnt(0)
    buffer_load_dword v172, v6, s[52:55], s16 offen offset:2304 sc1
    buffer_load_dword v173, v6, s[52:55], s16 offen offset:2816 sc1
    s_add_u32 s17, s78, 36864
    buffer_load_dwordx4 v[144:147], v12, s[52:55], s17 offen sc1
    buffer_load_dwordx4 v[148:151], v13, s[52:55], s17 offen sc1
    buffer_load_dwordx4 v[152:155], v14, s[52:55], s17 offen sc1
    buffer_load_dwordx4 v[156:159], v15, s[52:55], s17 offen sc1
    s_waitcnt vmcnt(0)
    v_bitop3_b32 v5, v172, v173, v144 bitop3:0x96
    v_bitop3_b32 v5, v5, v145, v146 bitop3:0x96
    v_bitop3_b32 v5, v5, v147, v148 bitop3:0x96
    v_bitop3_b32 v5, v5, v149, v150 bitop3:0x96
    v_bitop3_b32 v5, v5, v151, v152 bitop3:0x96
    v_bitop3_b32 v5, v5, v153, v154 bitop3:0x96
    v_bitop3_b32 v5, v5, v155, v156 bitop3:0x96
    v_bitop3_b32 v5, v5, v157, v158 bitop3:0x96
    v_xor_b32 v5, v5, v159
    v_cmp_ne_u32 vcc, s20, v5
    s_cbranch_vccnz L_g2_fix7
    s_branch L_g2_back7
L_g2_fix8:
    s_add_u32 s19, s19, 1
    s_cmp_gt_u32 s19, 4194304
    s_cbranch_scc1 L_g2_back8
    s_waitcnt vmcnt(0)
    buffer_load_dword v174, v6, s[52:55], s16 offen offset:3328 sc1
    buffer_load_dword v175, v6, s[52:55], s16 offen offset:3840 sc1
    s_add_u32 s17, s78, 49152
    buffer_load_dwordx4 v[32:35], v12, s[52:55], s17 offen sc1
    buffer_load_dwordx4 v[36:39], v13, s[52:55], s17 offen sc1
    buffer_load_dwordx4 v[40:43], v14, s[52:55], s17 offen sc1
    buffer_load_dwordx4 v[44:47], v15, s[52:55], s17 offen sc1
    s_waitcnt vmcnt(0)
    v_bitop3_b32 v4, v174, v175, v32 bitop3:0x96
    v_bitop3_b32 v4, v4, v33, v34 bitop3:0x96
    v_bitop3_b32 v4, v4, v35, v36 bitop3:0x96
    v_bitop3_b32 v4, v4, v37, v38 bitop3:0x96
    v_bitop3_b32 v4, v4, v39, v40 bitop3:0x96
    v_bitop3_b32 v4, v4, v41, v42 bitop3:0x96
    v_bitop3_b32 v4, v4, v43, v44 bitop3:0x96
    v_bitop3_b32 v4, v4, v45, v46 bitop3:0x96
    v_xor_b32 v4, v4, v47
    v_cmp_ne_u32 vcc, s20, v4
    s_cbranch_vccnz L_g2_fix8
    s_branch L_g2_back8
L_g2_fix9:
    s_add_u32 s19, s19, 1
    s_cmp_gt_u32 s19, 4194304
    s_cbranch_scc1 L_g2_back9
    s_waitcnt vmcnt(0)
    buffer_load_dwordx2 v[176:177], v9, s[52:55], s15 offen offset:1024 sc1
    buffer_load_dwordx2 v[178:179], v9, s[52:55], s15 offen offset:1536 sc1
    s_add_u32 s17, s78, 53248
    buffer_load_dwordx4 v[48:51], v12, s[52:55], s17 offen sc1
    buffer_load_dwordx4 v[52:55], v13, s[52:55], s17 offen sc1
    buffer_load_dwordx4 v[56:59], v14, s[52:55], s17 offen sc1
    buffer_load_dwordx4 v[60:63], v15, s[52:55], s17 offen sc1
    s_waitcnt vmcnt(0)
    v_bitop3_b32 v5, v176, v177, v178 bitop3:0x96
    v_bitop3_b32 v5, v5, v179, v48 bitop3:0x96
    v_bitop3_b32 v5, v5, v49, v50 bitop3:0x96
    v_bitop3_b32 v5, v5, v51, v52 bitop3:0x96
    v_bitop3_b32 v5, v5, v53, v54 bitop3:0x96
    v_bitop3_b32 v5, v5, v55, v56 bitop3:0x96
    v_bitop3_b32 v5, v5, v57, v58 bitop3:0x96
    v_bitop3_b32 v5, v5, v59, v60 bitop3:0x96
    v_bitop3_b32 v5, v5, v61, v62 bitop3:0x96
    v_xor_b32 v5, v5, v63
    v_cmp_ne_u32 vcc, s21, v5
    s_cbranch_vccnz L_g2_fix9
    s_branch L_g2_back9
L_warm_ret:
    s_endpgm
.section .rodata,"a"
.p2align 6
.amdhsa_kernel adaLN_cond__ssm_conv_h3__dense_activation_silu__prompt_kernel
  .amdhsa_next_free_vgpr 512
  .amdhsa_next_free_sgpr 102
  .amdhsa_accum_offset 256
  .amdhsa_group_segment_fixed_size 0
  .amdhsa_kernarg_size 112
  .amdhsa_user_sgpr_count 2
  .amdhsa_user_sgpr_kernarg_segment_ptr 1
  .amdhsa_system_sgpr_workgroup_id_x 1
  .amdhsa_float_denorm_mode_32 3
  .amdhsa_float_denorm_mode_16_64 3
.end_amdhsa_kernel
```
